```python
import torch

def _softmax(x, axis=-1):
    return torch.softmax(x, dim=axis)
def _gelu(x):
    return torch.nn.functional.gelu(x, approximate="tanh")
def _silu(x):
    return torch.nn.functional.silu(x)
def _sigmoid(x):
    return torch.sigmoid(x)
def _layernorm(x, axis=-1, eps=1e-5):
    m = x.mean(dim=axis, keepdim=True)
    v = x.var(dim=axis, keepdim=True, unbiased=False)
    return (x - m) / torch.sqrt(v + eps)
def _scatter_add(tgt, idx, src, axis=0):
    return tgt.clone().index_add_(axis, idx, src)
def _segment_sum(src, seg, n):
    out = torch.zeros((n,) + src.shape[1:], dtype=src.dtype)
    return out.index_add_(0, seg, src)
def _pad(x, pw):
    flat = tuple(v for pair in reversed(pw) for v in pair)
    return torch.nn.functional.pad(x, flat)

kernel_name = 'parallel_sum__grouped_kv_mqa__glu_gated_swiglu__prompt'

def setup_inputs():

    _w = (lambda a: (lambda t: t.to(torch.bfloat16) if t.is_floating_point() else t)(torch.as_tensor(a)))
    def _A_setup():
        B, S, D, H = 1, 2048, 576, 32
        Dh = D // H
        return {
            "x": _w((lambda *s: torch.randn(*s, dtype=torch.bfloat16) * 0.05)(B, S, D)),
            "wq": _w((lambda *s: torch.randn(*s, dtype=torch.bfloat16) * 0.05)(D, H * Dh)),
            "wk": _w((lambda *s: torch.randn(*s, dtype=torch.bfloat16) * 0.05)(D, Dh)),
            "wv": _w((lambda *s: torch.randn(*s, dtype=torch.bfloat16) * 0.05)(D, Dh)),
            "wo": _w((lambda *s: torch.randn(*s, dtype=torch.bfloat16) * 0.05)(H * Dh, D)),
        }
    _A_in = _A_setup()

    def _B_setup():
        B, S, D, F = 1, 2048, 576, 4608
        return {
            "x": _w((lambda *s: torch.randn(*s, dtype=torch.bfloat16) * 0.05)(B, S, D)),
            "w1": _w((lambda *s: torch.randn(*s, dtype=torch.bfloat16) * 0.4)(D, F) * (2.0 / D) ** 0.5),
            "w3": _w((lambda *s: torch.randn(*s, dtype=torch.bfloat16) * 0.4)(D, F) * (2.0 / D) ** 0.5),
            "w2": _w((lambda *s: torch.randn(*s, dtype=torch.bfloat16) * 0.4)(F, D) * (2.0 / F) ** 0.5),
        }
    _B_in = _B_setup()

    return {
        "A_x": _A_in["x"],
        "A_wq": _A_in["wq"],
        "A_wk": _A_in["wk"],
        "A_wv": _A_in["wv"],
        "A_wo": _A_in["wo"],
        "B_x": _B_in["x"],
        "B_w1": _B_in["w1"],
        "B_w3": _B_in["w3"],
        "B_w2": _B_in["w2"],
    }

def reference(A_x, A_wq, A_wk, A_wv, A_wo, B_x, B_w1, B_w3, B_w2):
    def _A_ref(x, wq, wk, wv, wo):
        B, S, D = x.shape
        H = 32
        Dh = D // H
        q = (lambda x, *d: x.permute(*d))((x @ wq).reshape(B, S, H, Dh), 0, 2, 1, 3)
        k = x @ wk
        v = x @ wv
        scores = torch.einsum("bhqd,bkd->bhqk", q, k) * (Dh ** -0.5)
        p = _softmax(scores, axis=-1)
        o = torch.einsum("bhqk,bkd->bhqd", p, v)
        return (lambda x, *d: x.permute(*d))(o, 0, 2, 1, 3).reshape(B, S, H * Dh) @ wo

    def _B_ref(x, w1, w3, w2):
        gate = torch.einsum("bsd,df->bsf", x, w1)
        up = torch.einsum("bsd,df->bsf", x, w3)
        h = _silu(gate) * up
        out = torch.einsum("bsf,fd->bsd", h, w2)
        return out

    x = A_x
    xn = _layernorm(x, axis=-1)
    return x + _A_ref(xn, A_wq, A_wk, A_wv, A_wo) + _B_ref(xn, B_w1, B_w3, B_w2)
```

```asm
; @launch kernel=k1_kernel grid=(256,1,1) block=(512,1,1) lds=163840
; @launch kernel=k2_kernel grid=(512,1,1) block=(256,1,1) lds=81920
; @launch kernel=k3_kernel grid=(248,1,1) block=(320,1,1) lds=73728
.amdgcn_target "amdgcn-amd-amdhsa--gfx950"
.text
.globl k1_kernel
.p2align 8
.type k1_kernel,@function
k1_kernel:
    s_cmp_ge_u32 s2, 256
    s_cbranch_scc1 K1_EXIT
    s_load_dwordx8 s[4:11], s[0:1], 0
    s_load_dwordx4 s[12:15], s[0:1], 48
    s_load_dwordx4 s[64:67], s[0:1], 80
    v_and_b32 v255, 63, v0
    v_lshrrev_b32 v246, 6, v0
    s_and_b32 s40, s2, 7
    s_lshl_b32 s40, s40, 2
    v_readfirstlane_b32 s42, v246
    s_lshr_b32 s57, s2, 3
    s_and_b32 s58, s57, 3
    s_add_u32 s40, s40, s58
    s_lshr_b32 s41, s57, 2
    s_and_b32 s43, s42, 3
    s_lshr_b32 s44, s42, 2
    s_mov_b32 s56, 0xffff0000
    s_cmp_lg_u32 s42, 7
    s_cbranch_scc1 K1_NOCPF
    s_lshr_b32 s57, s2, 3
    s_getpc_b64 s[20:21]
CPF1:
    s_add_u32 s20, s20, K1_PROD0-CPF1
    s_addc_u32 s21, s21, 0
    s_lshl_b32 s22, s57, 13
    v_lshl_add_u32 v194, v255, 7, s22
    v_mov_b32 v193, s21
    v_add_co_u32 v192, vcc, s20, v194
    s_nop 1
    v_addc_co_u32 v193, vcc, 0, v193, vcc
    v_cmp_gt_u32 vcc, K3_EXIT-K1_PROD0, v194
    s_and_saveexec_b64 s[20:21], vcc
    s_cbranch_execz CPF1_skip
    global_load_dword v195, v[192:193], off
CPF1_skip:
    s_mov_b64 exec, -1
K1_NOCPF:
    v_lshlrev_b32 v228, 4, v255
    v_lshrrev_b32 v229, 5, v255
    v_lshlrev_b32 v229, 30, v229
    v_lshl_add_u32 v229, v255, 2, v229
    v_add_u32 v229, 1024, v229
    v_lshrrev_b32 v246, 3, v255
    v_mul_u32_u24 v246, 1152, v246
    v_and_b32 v247, 7, v255
    v_lshrrev_b32 v248, 4, v255
    v_xor_b32 v247, v247, v248
    v_lshl_add_u32 v243, v247, 4, v246
    v_xor_b32 v247, 4, v247
    v_lshl_add_u32 v244, v247, 4, v246
    v_mul_u32_u24 v246, 3641, v0
    v_lshrrev_b32 v246, 16, v246
    v_mul_u32_u24 v247, 18, v246
    v_sub_u32 v247, v0, v247
    v_lshrrev_b32 v248, 1, v246
    v_xor_b32 v248, v248, v246
    v_and_b32 v248, 4, v248
    v_mul_u32_u24 v248, 3, v248
    v_xor_b32 v246, v246, v248
    v_mul_u32_u24 v246, 9216, v246
    v_lshl_add_u32 v241, v247, 4, v246
    s_lshl_b32 s57, s41, 8
    s_lshl_b32 s58, s40, 3
    s_add_u32 s63, s57, s58
    s_add_u32 s63, s63, s42
    s_mov_b32 s50, s63
    s_mul_i32 s63, s63, 1152
    s_lshl_b32 s58, s42, 5
    s_add_u32 s57, s57, s58
    s_mul_i32 s45, s57, 1152
    s_mul_i32 s61, s40, 288
    s_mul_i32 s58, s41, 11
    s_lshr_b32 s58, s58, 5
    s_lshl_b32 s101, 1, s58
    s_mul_i32 s58, s58, 3
    s_sub_u32 s60, s41, s58
    s_mul_i32 s60, s60, 3
    s_cmp_eq_u32 s41, 2
    s_cselect_b32 s101, 5, s101
    s_mov_b32 s19, s60
    s_lshl_b32 s18, s60, 1
    s_mov_b32 s3, s18
    s_lshl_b32 s54, s42, 10
    s_add_u32 s54, s54, 32768
    s_lshl_b32 s55, s42, 12
    s_waitcnt lgkmcnt(0)
    s_mov_b32 s20, s4
    s_and_b32 s21, s5, 0xffff
    s_mov_b32 s22, 0x240000
    s_mov_b32 s23, 0x00020000
    s_mov_b32 s24, s12
    s_and_b32 s25, s13, 0xffff
    s_mov_b32 s26, 0x510000
    s_mov_b32 s27, 0x00020000
    s_mov_b32 s28, s14
    s_and_b32 s29, s15, 0xffff
    s_mov_b32 s30, 0x510000
    s_mov_b32 s31, 0x00020000
    s_mov_b32 s35, 0x00020000
    v_lshrrev_b32 v246, 2, v255
    v_and_b32 v247, 3, v255
    s_and_b32 s57, s42, 1
    s_lshl_b32 s49, s57, 10
    s_cmp_ge_u32 s42, 4
    s_cbranch_scc1 K1_E_KV
    s_cmp_ge_u32 s42, 2
    s_cbranch_scc1 K1_E_WQ
    s_cmp_eq_u32 s42, 0
    s_cselect_b32 s32, s12, s14
    s_cselect_b32 s33, s13, s15
    s_cselect_b32 s49, 0, 9216
    s_add_u32 s49, s49, 40960
    s_and_b32 s33, s33, 0xffff
    s_mov_b32 s34, 0x510000
    v_add_u32 v249, 512, v255
    v_mul_u32_u24 v246, 3641, v249
    v_lshrrev_b32 v246, 16, v246
    v_mul_u32_u24 v247, 18, v246
    v_sub_u32 v247, v249, v247
    v_lshrrev_b32 v248, 1, v246
    v_xor_b32 v248, v248, v246
    v_and_b32 v248, 4, v248
    v_mul_u32_u24 v248, 3, v248
    v_xor_b32 v246, v246, v248
    v_mul_u32_u24 v246, 9216, v246
    v_lshl_add_u32 v242, v247, 4, v246
    s_mov_b32 s62, s61
    s_mov_b32 s48, 294912
    s_branch K1_E_DONE
K1_E_WQ:
    s_mov_b32 s32, s6
    s_and_b32 s33, s7, 0xffff
    s_mov_b32 s34, 0xa2000
    s_add_u32 s49, s49, 51200
    v_lshrrev_b32 v248, 1, v246
    v_xor_b32 v248, v248, v246
    v_and_b32 v248, 4, v248
    v_mul_u32_u24 v248, 3, v248
    v_xor_b32 v246, v246, v248
    v_mul_u32_u24 v246, 1152, v246
    v_lshl_add_u32 v242, v247, 4, v246
    s_mul_i32 s62, s57, 18432
    s_mul_i32 s57, s40, 36
    s_add_u32 s62, s62, s57
    s_mov_b32 s48, 36864
    s_branch K1_E_DONE
K1_E_KV:
    s_cmp_lt_u32 s40, 3
    s_cselect_b32 s32, s8, s10
    s_cselect_b32 s33, s9, s11
    s_cselect_b32 s58, 0, 3
    s_and_b32 s33, s33, 0xffff
    s_mov_b32 s34, 0x5100
    s_sub_u32 s58, s40, s58
    s_min_u32 s58, s58, 2
    s_add_u32 s49, s49, 53248
    v_lshrrev_b32 v248, 1, v246
    v_xor_b32 v248, v248, v246
    v_and_b32 v248, 4, v248
    v_mul_u32_u24 v248, 3, v248
    v_xor_b32 v246, v246, v248
    v_mul_u32_u24 v246, 36, v246
    v_lshl_add_u32 v242, v247, 4, v246
    s_mul_i32 s62, s57, 576
    s_mul_i32 s57, s58, 12
    s_add_u32 s62, s62, s57
    s_mov_b32 s48, 1152
    s_cmp_ge_u32 s40, 6
    s_cselect_b32 s34, 0, s34
    s_cmp_ge_u32 s42, 6
    s_cselect_b32 s34, 0, s34
    s_cselect_b32 s49, 55296, s49
K1_E_DONE:
    s_mov_b32 s52, 0
    s_mov_b32 s53, 81920
    s_mul_i32 s46, s3, 294912
    s_add_u32 s57, s52, s54
    s_add_u32 m0, s57, 0
    s_add_u32 s46, s46, s61
    buffer_load_dwordx4 v241, s[24:27], s46 offen lds
    s_add_u32 m0, s57, 9216
    s_mul_i32 s47, s3, s48
    buffer_load_dwordx4 v241, s[28:31], s46 offen lds
    s_add_u32 s47, s47, s62
    s_add_u32 s57, s52, s49
    s_add_u32 m0, s57, 0
    s_add_u32 s3, s3, 1
    buffer_load_dwordx4 v242, s[32:35], s47 offen lds
    s_cmp_eq_u32 s3, 18
    s_cselect_b32 s3, 0, s3
    s_cmp_eq_u32 s3, s18
    s_cselect_b32 s3, 64, s3
    s_lshl_b32 s58, s19, 7
    s_add_u32 s58, s58, s45
    s_add_u32 s19, s19, 1
    s_cmp_eq_u32 s19, 9
    s_cselect_b32 s19, 0, s19
    s_cmp_eq_u32 s19, s60
    s_cselect_b32 s19, 0x800000, s19
    s_add_u32 m0, s52, s55
    s_nop 0
    buffer_load_dwordx4 v243, s[20:23], s58 offen lds
    s_add_u32 m0, m0, 1024
    s_add_u32 s58, s58, 9216
    buffer_load_dwordx4 v244, s[20:23], s58 offen lds
    s_add_u32 m0, m0, 1024
    s_add_u32 s58, s58, 9216
    buffer_load_dwordx4 v243, s[20:23], s58 offen lds
    s_add_u32 m0, m0, 1024
    s_add_u32 s58, s58, 9216
    buffer_load_dwordx4 v244, s[20:23], s58 offen lds
    s_mul_i32 s46, s3, 294912
    s_add_u32 s57, s52, s54
    s_add_u32 m0, s57, 23552
    s_add_u32 s46, s46, s61
    buffer_load_dwordx4 v241, s[24:27], s46 offen lds
    s_add_u32 m0, s57, 32768
    s_mul_i32 s47, s3, s48
    buffer_load_dwordx4 v241, s[28:31], s46 offen lds
    s_add_u32 s47, s47, s62
    s_add_u32 s57, s52, s49
    s_add_u32 m0, s57, 23552
    s_add_u32 s3, s3, 1
    buffer_load_dwordx4 v242, s[32:35], s47 offen lds
    s_cmp_eq_u32 s3, 18
    s_cselect_b32 s3, 0, s3
    s_cmp_eq_u32 s3, s18
    s_cselect_b32 s3, 64, s3
    buffer_load_dwordx4 v[176:179], v228, s[20:23], s63 offen
    buffer_load_dword v180, v229, s[20:23], s63 offen
    s_mov_b32 s36, s66
    s_and_b32 s37, s67, 0xffff
    s_mov_b32 s38, 0x10000000
    s_mov_b32 s39, 0x00020000
    s_and_b32 s65, s65, 0xffff
    s_mov_b32 s66, 256
    s_mov_b32 s67, 0x00020000
    v_and_b32 v246, 15, v255
    v_lshrrev_b32 v247, 4, v255
    v_lshrrev_b32 v248, 1, v246
    v_xor_b32 v248, v248, v247
    s_lshl_b32 s57, s43, 13
    v_lshl_add_u32 v246, v246, 7, s57
    v_lshl_add_u32 v236, v248, 4, v246
    v_xor_b32 v248, 4, v248
    v_lshl_add_u32 v237, v248, 4, v246
    v_bfe_u32 v246, v255, 2, 3
    v_lshrrev_b32 v248, 5, v255
    v_lshl_add_u32 v246, v248, 4, v246
    v_and_b32 v249, 3, v255
    v_mul_u32_u24 v238, 288, v246
    v_lshl_add_u32 v238, v249, 3, v238
    s_mul_i32 s57, s44, 160
    s_add_u32 s57, s57, 32768
    v_add_u32 v238, s57, v238
    v_lshlrev_b32 v239, 6, v246
    v_add_u32 v239, 32768, v239
    v_add_u32 v248, 32, v239
    v_lshl_add_u32 v239, v249, 3, v239
    v_add_u32 v240, 2040, v239
    v_cmp_eq_u32 vcc, 0, v249
    v_mov_b32 v246, 81152
    v_mov_b32 v247, 0
    v_cndmask_b32 v240, v240, v248, vcc
    ds_write_b32 v246, v247
    v_mov_b64 v[0:1], 0
    v_mov_b64 v[2:3], 0
    v_mov_b64 v[4:5], 0
    v_mov_b64 v[6:7], 0
    v_mov_b64 v[8:9], 0
    v_mov_b64 v[10:11], 0
    v_mov_b64 v[12:13], 0
    v_mov_b64 v[14:15], 0
    v_mov_b64 v[16:17], 0
    v_mov_b64 v[18:19], 0
    v_mov_b64 v[20:21], 0
    v_mov_b64 v[22:23], 0
    v_mov_b64 v[24:25], 0
    v_mov_b64 v[26:27], 0
    v_mov_b64 v[28:29], 0
    v_mov_b64 v[30:31], 0
    v_mov_b64 v[32:33], 0
    v_mov_b64 v[34:35], 0
    v_mov_b64 v[36:37], 0
    v_mov_b64 v[38:39], 0
    v_mov_b64 v[40:41], 0
    v_mov_b64 v[42:43], 0
    v_mov_b64 v[44:45], 0
    v_mov_b64 v[46:47], 0
    v_mov_b64 v[48:49], 0
    v_mov_b64 v[50:51], 0
    v_mov_b64 v[52:53], 0
    v_mov_b64 v[54:55], 0
    v_mov_b64 v[56:57], 0
    v_mov_b64 v[58:59], 0
    v_mov_b64 v[60:61], 0
    v_mov_b64 v[62:63], 0
    v_mov_b64 v[64:65], 0
    v_mov_b64 v[66:67], 0
    v_mov_b64 v[68:69], 0
    v_mov_b64 v[70:71], 0
    v_mov_b64 v[72:73], 0
    v_mov_b64 v[74:75], 0
    v_mov_b64 v[76:77], 0
    v_mov_b64 v[78:79], 0
    v_mov_b64 v[80:81], 0
    v_mov_b64 v[82:83], 0
    v_mov_b64 v[84:85], 0
    v_mov_b64 v[86:87], 0
    v_mov_b64 v[88:89], 0
    v_mov_b64 v[90:91], 0
    v_mov_b64 v[92:93], 0
    v_mov_b64 v[94:95], 0
    v_mov_b64 v[96:97], 0
    v_mov_b64 v[98:99], 0
    v_mov_b64 v[100:101], 0
    v_mov_b64 v[102:103], 0
    v_mov_b64 v[104:105], 0
    v_mov_b64 v[106:107], 0
    v_mov_b64 v[108:109], 0
    v_mov_b64 v[110:111], 0
    v_mov_b64 v[112:113], 0
    v_mov_b64 v[114:115], 0
    v_mov_b64 v[116:117], 0
    v_mov_b64 v[118:119], 0
    v_mov_b64 v[120:121], 0
    v_mov_b64 v[122:123], 0
    v_mov_b64 v[124:125], 0
    v_mov_b64 v[126:127], 0
    v_mov_b64 v[128:129], 0
    v_mov_b64 v[130:131], 0
    v_mov_b64 v[132:133], 0
    v_mov_b64 v[134:135], 0
    v_mov_b64 v[136:137], 0
    v_mov_b64 v[138:139], 0
    v_mov_b64 v[140:141], 0
    v_mov_b64 v[142:143], 0
    v_mov_b64 v[144:145], 0
    v_mov_b64 v[146:147], 0
    v_mov_b64 v[148:149], 0
    v_mov_b64 v[150:151], 0
    v_mov_b64 v[152:153], 0
    v_mov_b64 v[154:155], 0
    v_mov_b64 v[156:157], 0
    v_mov_b64 v[158:159], 0
    v_mov_b64 v[212:213], 0
    v_mov_b64 v[214:215], 0
    v_mov_b64 v[216:217], 0
    v_mov_b64 v[218:219], 0
    v_mov_b64 v[220:221], 0
    v_mov_b64 v[222:223], 0
    v_mov_b32 v224, 0x3f803f80
    v_mov_b32 v225, 0x3f803f80
    v_mov_b32 v226, 0x3f803f80
    v_mov_b32 v227, 0x3f803f80
    s_lshl_b32 s63, s50, 4
    s_add_u32 s63, s63, 44040192
    s_lshr_b32 s57, s2, 3
    s_and_b32 s57, s57, 1
    s_lshl_b32 s57, 16, s57
    s_cmp_eq_u32 s42, 0
    s_cselect_b32 s17, s57, 0
    s_or_b32 s17, s17, 136
    s_mov_b32 s50, 0
    s_mov_b32 s51, 81920
    s_mov_b32 s59, 0xfffec000
    s_waitcnt vmcnt(5) lgkmcnt(0)
    s_barrier
    ds_read_b128 v[160:163], v236 offset:0
    ds_read_b128 v[164:167], v236 offset:2048
    ds_read_b128 v[168:171], v236 offset:4096
    ds_read_b128 v[172:175], v236 offset:6144
    ds_read_b64_tr_b16 v[192:193], v238 offset:0
    ds_read_b64_tr_b16 v[194:195], v238 offset:2304
    ds_read_b64_tr_b16 v[196:197], v238 offset:9216
    ds_read_b64_tr_b16 v[198:199], v238 offset:11520
    ds_read_b64_tr_b16 v[200:201], v238 offset:32
    ds_read_b64_tr_b16 v[202:203], v238 offset:2336
    ds_read_b64_tr_b16 v[204:205], v238 offset:9248
    ds_read_b64_tr_b16 v[206:207], v238 offset:11552
    v_add_u32 v236, s51, v236
    s_mul_i32 s46, s3, 294912
    s_add_u32 s57, s53, s54
    s_add_u32 m0, s57, 0
    s_add_u32 s46, s46, s61
    buffer_load_dwordx4 v241, s[24:27], s46 offen lds
    s_add_u32 m0, s57, 9216
    s_mul_i32 s47, s3, s48
    buffer_load_dwordx4 v241, s[28:31], s46 offen lds
    s_add_u32 s47, s47, s62
    s_add_u32 s57, s53, s49
    s_add_u32 m0, s57, 0
    s_add_u32 s3, s3, 1
    buffer_load_dwordx4 v242, s[32:35], s47 offen lds
    s_cmp_eq_u32 s3, 18
    s_cselect_b32 s3, 0, s3
    s_cmp_eq_u32 s3, s18
    s_cselect_b32 s3, 64, s3
    s_lshl_b32 s58, s19, 7
    s_add_u32 s58, s58, s45
    s_add_u32 s19, s19, 1
    s_cmp_eq_u32 s19, 9
    s_cselect_b32 s19, 0, s19
    s_cmp_eq_u32 s19, s60
    s_cselect_b32 s19, 0x800000, s19
    s_add_u32 m0, s53, s55
    s_nop 0
    buffer_load_dwordx4 v243, s[20:23], s58 offen lds
    s_add_u32 m0, m0, 1024
    s_add_u32 s58, s58, 9216
    buffer_load_dwordx4 v244, s[20:23], s58 offen lds
    s_add_u32 m0, m0, 1024
    s_add_u32 s58, s58, 9216
    buffer_load_dwordx4 v243, s[20:23], s58 offen lds
    s_add_u32 m0, m0, 1024
    s_add_u32 s58, s58, 9216
    buffer_load_dwordx4 v244, s[20:23], s58 offen lds
    s_waitcnt vmcnt(7)
    v_and_b32 v181, s56, v176
    v_lshlrev_b32 v182, 16, v176
    v_and_b32 v183, s56, v177
    v_lshlrev_b32 v184, 16, v177
    v_and_b32 v185, s56, v178
    v_lshlrev_b32 v186, 16, v178
    v_and_b32 v187, s56, v179
    v_lshlrev_b32 v188, 16, v179
    v_and_b32 v189, s56, v180
    v_lshlrev_b32 v190, 16, v180
    v_add_f32 v191, v181, v182
    v_add_f32 v191, v191, v183
    v_add_f32 v191, v191, v184
    v_add_f32 v191, v191, v185
    v_add_f32 v191, v191, v186
    v_add_f32 v191, v191, v187
    v_add_f32 v191, v191, v188
    v_add_f32 v191, v191, v189
    v_add_f32 v191, v191, v190
    s_nop 1
    v_add_f32_dpp v191, v191, v191 row_shr:1 row_mask:0xf bank_mask:0xf bound_ctrl:0
    s_nop 1
    v_add_f32_dpp v191, v191, v191 row_shr:2 row_mask:0xf bank_mask:0xf bound_ctrl:0
    s_nop 1
    v_add_f32_dpp v191, v191, v191 row_shr:4 row_mask:0xf bank_mask:0xf bound_ctrl:0
    s_nop 1
    v_add_f32_dpp v191, v191, v191 row_shr:8 row_mask:0xf bank_mask:0xf bound_ctrl:0
    s_nop 1
    v_add_f32_dpp v191, v191, v191 row_bcast:15 row_mask:0xa bank_mask:0xf bound_ctrl:0
    s_nop 1
    v_add_f32_dpp v191, v191, v191 row_bcast:31 row_mask:0xc bank_mask:0xf bound_ctrl:0
    v_mul_f32 v191, 0x3ae38e39, v191
    s_nop 0
    v_readlane_b32 s57, v191, 63
    s_nop 1
    v_subrev_f32 v181, s57, v181
    v_subrev_f32 v182, s57, v182
    v_subrev_f32 v183, s57, v183
    v_subrev_f32 v184, s57, v184
    v_subrev_f32 v185, s57, v185
    v_subrev_f32 v186, s57, v186
    v_subrev_f32 v187, s57, v187
    v_subrev_f32 v188, s57, v188
    s_mov_b32 exec_hi, 0
    v_subrev_f32 v189, s57, v189
    v_subrev_f32 v190, s57, v190
    s_mov_b64 exec, -1
    v_mul_f32 v176, v181, v181
    v_fmac_f32 v176, v182, v182
    v_fmac_f32 v176, v183, v183
    v_fmac_f32 v176, v184, v184
    v_fmac_f32 v176, v185, v185
    v_fmac_f32 v176, v186, v186
    v_fmac_f32 v176, v187, v187
    v_fmac_f32 v176, v188, v188
    v_fmac_f32 v176, v189, v189
    v_fmac_f32 v176, v190, v190
    s_nop 1
    v_add_f32_dpp v176, v176, v176 row_shr:1 row_mask:0xf bank_mask:0xf bound_ctrl:0
    s_nop 1
    v_add_f32_dpp v176, v176, v176 row_shr:2 row_mask:0xf bank_mask:0xf bound_ctrl:0
    s_nop 1
    v_add_f32_dpp v176, v176, v176 row_shr:4 row_mask:0xf bank_mask:0xf bound_ctrl:0
    s_nop 1
    v_add_f32_dpp v176, v176, v176 row_shr:8 row_mask:0xf bank_mask:0xf bound_ctrl:0
    s_nop 1
    v_add_f32_dpp v176, v176, v176 row_bcast:15 row_mask:0xa bank_mask:0xf bound_ctrl:0
    s_nop 1
    v_add_f32_dpp v176, v176, v176 row_bcast:31 row_mask:0xc bank_mask:0xf bound_ctrl:0
    v_mul_f32 v176, 0x3ae38e39, v176
    v_cvt_pk_bf16_f32 v232, v191, v191
    v_and_b32 v232, s56, v232
    v_xor_b32 v232, 0x80000000, v232
    v_cvt_pk_bf16_f32 v176, v176, v176
    v_and_b32 v176, s56, v176
    v_add_f32 v176, 0x3727c5ac, v176
    v_cvt_pk_bf16_f32 v176, v176, v176
    v_and_b32 v176, s56, v176
    v_sqrt_f32 v176, v176
    s_nop 0
    v_cvt_pk_bf16_f32 v176, v176, v176
    v_and_b32 v176, s56, v176
    v_rcp_f32 v235, v176
    v_mul_f32 v234, v176, v176
    v_mul_f32 v233, 0xbfb8aa3b, v235
    v_mov_b32 v228, 0
    s_mov_b32 exec_lo, 0
    s_mov_b32 exec_hi, 0x80000000
    buffer_store_dwordx4 v[232:235], v228, s[36:39], s63 offen sc1
    s_mov_b64 exec, -1
    s_cmp_eq_u32 s44, 1
    s_cbranch_scc1 K1_HOOK1
    s_branch K1_HOOK0
K1_PROD0:
    s_waitcnt lgkmcnt(6)
    v_mfma_f32_16x16x32_bf16 v[0:3], v[192:195], v[160:163], v[0:3]
    ds_read_b64_tr_b16 v[208:209], v238 offset:64
    ds_read_b64_tr_b16 v[210:211], v238 offset:2368
    v_mfma_f32_16x16x32_bf16 v[4:7], v[192:195], v[164:167], v[4:7]
    v_mfma_f32_16x16x32_bf16 v[8:11], v[192:195], v[168:171], v[8:11]
    v_mfma_f32_16x16x32_bf16 v[12:15], v[192:195], v[172:175], v[12:15]
    s_cmp_lg_u32 s43, 0
    s_cbranch_scc1 K1_P0_0_0
    v_mfma_f32_16x16x32_bf16 v[212:215], v[192:195], v[224:227], v[212:215]
K1_P0_0_0:
    s_waitcnt lgkmcnt(6)
    v_mfma_f32_16x16x32_bf16 v[16:19], v[196:199], v[160:163], v[16:19]
    ds_read_b64_tr_b16 v[192:193], v238 offset:9280
    ds_read_b64_tr_b16 v[194:195], v238 offset:11584
    v_mfma_f32_16x16x32_bf16 v[20:23], v[196:199], v[164:167], v[20:23]
    v_mfma_f32_16x16x32_bf16 v[24:27], v[196:199], v[168:171], v[24:27]
    v_mfma_f32_16x16x32_bf16 v[28:31], v[196:199], v[172:175], v[28:31]
    s_cmp_lg_u32 s43, 1
    s_cbranch_scc1 K1_P0_0_1
    v_mfma_f32_16x16x32_bf16 v[212:215], v[196:199], v[224:227], v[212:215]
K1_P0_0_1:
    s_waitcnt vmcnt(7)
    s_barrier
    s_waitcnt lgkmcnt(6)
    v_mfma_f32_16x16x32_bf16 v[32:35], v[200:203], v[160:163], v[32:35]
    ds_read_b64_tr_b16 v[196:197], v238 offset:96
    ds_read_b64_tr_b16 v[198:199], v238 offset:2400
    v_mfma_f32_16x16x32_bf16 v[36:39], v[200:203], v[164:167], v[36:39]
    ds_read_b128 v[176:179], v237 offset:0
    v_mfma_f32_16x16x32_bf16 v[40:43], v[200:203], v[168:171], v[40:43]
    s_mul_i32 s46, s3, 294912
    s_add_u32 s57, s53, s54
    s_add_u32 m0, s57, 23552
    s_add_u32 s46, s46, s61
    buffer_load_dwordx4 v241, s[24:27], s46 offen lds
    v_mfma_f32_16x16x32_bf16 v[44:47], v[200:203], v[172:175], v[44:47]
    s_cmp_lg_u32 s43, 2
    s_cbranch_scc1 K1_P0_0_2
    v_mfma_f32_16x16x32_bf16 v[212:215], v[200:203], v[224:227], v[212:215]
K1_P0_0_2:
    s_waitcnt lgkmcnt(7)
    v_mfma_f32_16x16x32_bf16 v[48:51], v[204:207], v[160:163], v[48:51]
    ds_read_b64_tr_b16 v[200:201], v238 offset:9312
    ds_read_b64_tr_b16 v[202:203], v238 offset:11616
    v_mfma_f32_16x16x32_bf16 v[52:55], v[204:207], v[164:167], v[52:55]
    ds_read_b128 v[180:183], v237 offset:2048
    v_mfma_f32_16x16x32_bf16 v[56:59], v[204:207], v[168:171], v[56:59]
    s_add_u32 m0, s57, 32768
    s_mul_i32 s47, s3, s48
    buffer_load_dwordx4 v241, s[28:31], s46 offen lds
    s_add_u32 s47, s47, s62
    v_mfma_f32_16x16x32_bf16 v[60:63], v[204:207], v[172:175], v[60:63]
    s_cmp_lg_u32 s43, 3
    s_cbranch_scc1 K1_P0_0_3
    v_mfma_f32_16x16x32_bf16 v[212:215], v[204:207], v[224:227], v[212:215]
K1_P0_0_3:
    s_waitcnt lgkmcnt(8)
    v_mfma_f32_16x16x32_bf16 v[64:67], v[208:211], v[160:163], v[64:67]
    ds_read_b64_tr_b16 v[204:205], v238 offset:128
    ds_read_b64_tr_b16 v[206:207], v238 offset:2432
    v_mfma_f32_16x16x32_bf16 v[68:71], v[208:211], v[164:167], v[68:71]
    ds_read_b128 v[184:187], v237 offset:4096
    v_mfma_f32_16x16x32_bf16 v[72:75], v[208:211], v[168:171], v[72:75]
    s_add_u32 s57, s53, s49
    s_add_u32 m0, s57, 23552
    s_add_u32 s3, s3, 1
    buffer_load_dwordx4 v242, s[32:35], s47 offen lds
    s_cmp_eq_u32 s3, 18
    s_cselect_b32 s3, 0, s3
    s_cmp_eq_u32 s3, s18
    s_cselect_b32 s3, 64, s3
    v_mfma_f32_16x16x32_bf16 v[76:79], v[208:211], v[172:175], v[76:79]
    s_cmp_lg_u32 s43, 0
    s_cbranch_scc1 K1_P0_0_4
    v_mfma_f32_16x16x32_bf16 v[216:219], v[208:211], v[224:227], v[216:219]
K1_P0_0_4:
    s_waitcnt lgkmcnt(9)
    v_mfma_f32_16x16x32_bf16 v[80:83], v[192:195], v[160:163], v[80:83]
    ds_read_b64_tr_b16 v[208:209], v238 offset:9344
    ds_read_b64_tr_b16 v[210:211], v238 offset:11648
    v_mfma_f32_16x16x32_bf16 v[84:87], v[192:195], v[164:167], v[84:87]
    ds_read_b128 v[188:191], v237 offset:6144
    v_mfma_f32_16x16x32_bf16 v[88:91], v[192:195], v[168:171], v[88:91]
    v_mfma_f32_16x16x32_bf16 v[92:95], v[192:195], v[172:175], v[92:95]
    s_cmp_lg_u32 s43, 1
    s_cbranch_scc1 K1_P0_0_5
    v_mfma_f32_16x16x32_bf16 v[216:219], v[192:195], v[224:227], v[216:219]
K1_P0_0_5:
    s_waitcnt lgkmcnt(10)
    v_mfma_f32_16x16x32_bf16 v[96:99], v[196:199], v[160:163], v[96:99]
    ds_read_b64_tr_b16 v[192:193], v238 offset:23552
    ds_read_b64_tr_b16 v[194:195], v238 offset:25856
    v_mfma_f32_16x16x32_bf16 v[100:103], v[196:199], v[164:167], v[100:103]
    v_mfma_f32_16x16x32_bf16 v[104:107], v[196:199], v[168:171], v[104:107]
    v_mfma_f32_16x16x32_bf16 v[108:111], v[196:199], v[172:175], v[108:111]
    v_add_u32 v237, s51, v237
    s_cmp_lg_u32 s43, 2
    s_cbranch_scc1 K1_P0_0_6
    v_mfma_f32_16x16x32_bf16 v[216:219], v[196:199], v[224:227], v[216:219]
K1_P0_0_6:
    s_waitcnt lgkmcnt(9)
    v_mfma_f32_16x16x32_bf16 v[112:115], v[200:203], v[160:163], v[112:115]
    ds_read_b64_tr_b16 v[196:197], v238 offset:32768
    ds_read_b64_tr_b16 v[198:199], v238 offset:35072
    v_mfma_f32_16x16x32_bf16 v[116:119], v[200:203], v[164:167], v[116:119]
    v_mfma_f32_16x16x32_bf16 v[120:123], v[200:203], v[168:171], v[120:123]
    v_mfma_f32_16x16x32_bf16 v[124:127], v[200:203], v[172:175], v[124:127]
    s_cmp_lg_u32 s43, 3
    s_cbranch_scc1 K1_P0_0_7
    v_mfma_f32_16x16x32_bf16 v[216:219], v[200:203], v[224:227], v[216:219]
K1_P0_0_7:
    s_waitcnt lgkmcnt(8)
    v_mfma_f32_16x16x32_bf16 v[128:131], v[204:207], v[160:163], v[128:131]
    ds_read_b64_tr_b16 v[200:201], v238 offset:23584
    ds_read_b64_tr_b16 v[202:203], v238 offset:25888
    v_mfma_f32_16x16x32_bf16 v[132:135], v[204:207], v[164:167], v[132:135]
    v_mfma_f32_16x16x32_bf16 v[136:139], v[204:207], v[168:171], v[136:139]
    v_mfma_f32_16x16x32_bf16 v[140:143], v[204:207], v[172:175], v[140:143]
    s_cmp_lg_u32 s43, 0
    s_cbranch_scc1 K1_P0_0_8
    v_mfma_f32_16x16x32_bf16 v[220:223], v[204:207], v[224:227], v[220:223]
K1_P0_0_8:
    s_waitcnt lgkmcnt(7)
    v_mfma_f32_16x16x32_bf16 v[144:147], v[208:211], v[160:163], v[144:147]
    ds_read_b64_tr_b16 v[204:205], v238 offset:32800
    ds_read_b64_tr_b16 v[206:207], v238 offset:35104
    v_mfma_f32_16x16x32_bf16 v[148:151], v[208:211], v[164:167], v[148:151]
    v_mfma_f32_16x16x32_bf16 v[152:155], v[208:211], v[168:171], v[152:155]
    v_mfma_f32_16x16x32_bf16 v[156:159], v[208:211], v[172:175], v[156:159]
    s_cmp_lg_u32 s43, 1
    s_cbranch_scc1 K1_P0_0_9
    v_mfma_f32_16x16x32_bf16 v[220:223], v[208:211], v[224:227], v[220:223]
K1_P0_0_9:
    s_waitcnt lgkmcnt(6)
    v_mfma_f32_16x16x32_bf16 v[0:3], v[192:195], v[176:179], v[0:3]
    ds_read_b64_tr_b16 v[208:209], v238 offset:23616
    ds_read_b64_tr_b16 v[210:211], v238 offset:25920
    v_mfma_f32_16x16x32_bf16 v[4:7], v[192:195], v[180:183], v[4:7]
    v_mfma_f32_16x16x32_bf16 v[8:11], v[192:195], v[184:187], v[8:11]
    v_mfma_f32_16x16x32_bf16 v[12:15], v[192:195], v[188:191], v[12:15]
    s_cmp_lg_u32 s43, 0
    s_cbranch_scc1 K1_P0_1_0
    v_mfma_f32_16x16x32_bf16 v[212:215], v[192:195], v[224:227], v[212:215]
K1_P0_1_0:
    s_waitcnt lgkmcnt(6)
    v_mfma_f32_16x16x32_bf16 v[16:19], v[196:199], v[176:179], v[16:19]
    ds_read_b64_tr_b16 v[192:193], v238 offset:32832
    ds_read_b64_tr_b16 v[194:195], v238 offset:35136
    v_mfma_f32_16x16x32_bf16 v[20:23], v[196:199], v[180:183], v[20:23]
    v_mfma_f32_16x16x32_bf16 v[24:27], v[196:199], v[184:187], v[24:27]
    v_mfma_f32_16x16x32_bf16 v[28:31], v[196:199], v[188:191], v[28:31]
    s_cmp_lg_u32 s43, 1
    s_cbranch_scc1 K1_P0_1_1
    v_mfma_f32_16x16x32_bf16 v[212:215], v[196:199], v[224:227], v[212:215]
K1_P0_1_1:
    s_waitcnt vmcnt(3)
    s_barrier
    s_waitcnt lgkmcnt(6)
    v_mfma_f32_16x16x32_bf16 v[32:35], v[200:203], v[176:179], v[32:35]
    ds_read_b64_tr_b16 v[196:197], v238 offset:23648
    ds_read_b64_tr_b16 v[198:199], v238 offset:25952
    v_mfma_f32_16x16x32_bf16 v[36:39], v[200:203], v[180:183], v[36:39]
    ds_read_b128 v[160:163], v236 offset:0
    v_mfma_f32_16x16x32_bf16 v[40:43], v[200:203], v[184:187], v[40:43]
    s_mul_i32 s46, s3, 294912
    s_add_u32 s57, s52, s54
    s_add_u32 m0, s57, 0
    s_add_u32 s46, s46, s61
    buffer_load_dwordx4 v241, s[24:27], s46 offen lds
    v_mfma_f32_16x16x32_bf16 v[44:47], v[200:203], v[188:191], v[44:47]
    s_cmp_lg_u32 s43, 2
    s_cbranch_scc1 K1_P0_1_2
    v_mfma_f32_16x16x32_bf16 v[212:215], v[200:203], v[224:227], v[212:215]
K1_P0_1_2:
    s_waitcnt lgkmcnt(7)
    v_mfma_f32_16x16x32_bf16 v[48:51], v[204:207], v[176:179], v[48:51]
    ds_read_b64_tr_b16 v[200:201], v238 offset:32864
    ds_read_b64_tr_b16 v[202:203], v238 offset:35168
    v_mfma_f32_16x16x32_bf16 v[52:55], v[204:207], v[180:183], v[52:55]
    ds_read_b128 v[164:167], v236 offset:2048
    v_mfma_f32_16x16x32_bf16 v[56:59], v[204:207], v[184:187], v[56:59]
    s_add_u32 m0, s57, 9216
    s_mul_i32 s47, s3, s48
    buffer_load_dwordx4 v241, s[28:31], s46 offen lds
    s_add_u32 s47, s47, s62
    v_mfma_f32_16x16x32_bf16 v[60:63], v[204:207], v[188:191], v[60:63]
    s_cmp_lg_u32 s43, 3
    s_cbranch_scc1 K1_P0_1_3
    v_mfma_f32_16x16x32_bf16 v[212:215], v[204:207], v[224:227], v[212:215]
K1_P0_1_3:
    s_waitcnt lgkmcnt(8)
    v_mfma_f32_16x16x32_bf16 v[64:67], v[208:211], v[176:179], v[64:67]
    ds_read_b64_tr_b16 v[204:205], v238 offset:23680
    ds_read_b64_tr_b16 v[206:207], v238 offset:25984
    v_mfma_f32_16x16x32_bf16 v[68:71], v[208:211], v[180:183], v[68:71]
    ds_read_b128 v[168:171], v236 offset:4096
    v_mfma_f32_16x16x32_bf16 v[72:75], v[208:211], v[184:187], v[72:75]
    s_add_u32 s57, s52, s49
    s_add_u32 m0, s57, 0
    s_add_u32 s3, s3, 1
    buffer_load_dwordx4 v242, s[32:35], s47 offen lds
    s_cmp_eq_u32 s3, 18
    s_cselect_b32 s3, 0, s3
    s_cmp_eq_u32 s3, s18
    s_cselect_b32 s3, 64, s3
    v_mfma_f32_16x16x32_bf16 v[76:79], v[208:211], v[188:191], v[76:79]
    s_cmp_lg_u32 s43, 0
    s_cbranch_scc1 K1_P0_1_4
    v_mfma_f32_16x16x32_bf16 v[216:219], v[208:211], v[224:227], v[216:219]
K1_P0_1_4:
    s_waitcnt lgkmcnt(9)
    v_mfma_f32_16x16x32_bf16 v[80:83], v[192:195], v[176:179], v[80:83]
    ds_read_b64_tr_b16 v[208:209], v238 offset:32896
    ds_read_b64_tr_b16 v[210:211], v238 offset:35200
    v_mfma_f32_16x16x32_bf16 v[84:87], v[192:195], v[180:183], v[84:87]
    ds_read_b128 v[172:175], v236 offset:6144
    v_mfma_f32_16x16x32_bf16 v[88:91], v[192:195], v[184:187], v[88:91]
    s_lshl_b32 s58, s19, 7
    s_add_u32 s58, s58, s45
    s_add_u32 s19, s19, 1
    s_cmp_eq_u32 s19, 9
    s_cselect_b32 s19, 0, s19
    s_cmp_eq_u32 s19, s60
    s_cselect_b32 s19, 0x800000, s19
    v_mfma_f32_16x16x32_bf16 v[92:95], v[192:195], v[188:191], v[92:95]
    s_cmp_lg_u32 s43, 1
    s_cbranch_scc1 K1_P0_1_5
    v_mfma_f32_16x16x32_bf16 v[216:219], v[192:195], v[224:227], v[216:219]
K1_P0_1_5:
    s_waitcnt lgkmcnt(10)
    v_add_u32 v238, s51, v238
    v_mfma_f32_16x16x32_bf16 v[96:99], v[196:199], v[176:179], v[96:99]
    ds_read_b64_tr_b16 v[192:193], v238 offset:0
    ds_read_b64_tr_b16 v[194:195], v238 offset:2304
    v_mfma_f32_16x16x32_bf16 v[100:103], v[196:199], v[180:183], v[100:103]
    v_mfma_f32_16x16x32_bf16 v[104:107], v[196:199], v[184:187], v[104:107]
    s_add_u32 m0, s52, s55
    s_nop 0
    buffer_load_dwordx4 v243, s[20:23], s58 offen lds
    v_mfma_f32_16x16x32_bf16 v[108:111], v[196:199], v[188:191], v[108:111]
    v_add_u32 v236, s59, v236
    s_cmp_lg_u32 s43, 2
    s_cbranch_scc1 K1_P0_1_6
    v_mfma_f32_16x16x32_bf16 v[216:219], v[196:199], v[224:227], v[216:219]
K1_P0_1_6:
    s_waitcnt lgkmcnt(9)
    v_mfma_f32_16x16x32_bf16 v[112:115], v[200:203], v[176:179], v[112:115]
    ds_read_b64_tr_b16 v[196:197], v238 offset:9216
    ds_read_b64_tr_b16 v[198:199], v238 offset:11520
    v_mfma_f32_16x16x32_bf16 v[116:119], v[200:203], v[180:183], v[116:119]
    v_mfma_f32_16x16x32_bf16 v[120:123], v[200:203], v[184:187], v[120:123]
    s_add_u32 m0, m0, 1024
    s_add_u32 s58, s58, 9216
    buffer_load_dwordx4 v244, s[20:23], s58 offen lds
    v_mfma_f32_16x16x32_bf16 v[124:127], v[200:203], v[188:191], v[124:127]
    s_cmp_lg_u32 s43, 3
    s_cbranch_scc1 K1_P0_1_7
    v_mfma_f32_16x16x32_bf16 v[216:219], v[200:203], v[224:227], v[216:219]
K1_P0_1_7:
    s_waitcnt lgkmcnt(8)
    v_mfma_f32_16x16x32_bf16 v[128:131], v[204:207], v[176:179], v[128:131]
    ds_read_b64_tr_b16 v[200:201], v238 offset:32
    ds_read_b64_tr_b16 v[202:203], v238 offset:2336
    v_mfma_f32_16x16x32_bf16 v[132:135], v[204:207], v[180:183], v[132:135]
    v_mfma_f32_16x16x32_bf16 v[136:139], v[204:207], v[184:187], v[136:139]
    s_add_u32 m0, m0, 1024
    s_add_u32 s58, s58, 9216
    buffer_load_dwordx4 v243, s[20:23], s58 offen lds
    v_mfma_f32_16x16x32_bf16 v[140:143], v[204:207], v[188:191], v[140:143]
    s_cmp_lg_u32 s43, 0
    s_cbranch_scc1 K1_P0_1_8
    v_mfma_f32_16x16x32_bf16 v[220:223], v[204:207], v[224:227], v[220:223]
K1_P0_1_8:
    s_waitcnt lgkmcnt(7)
    v_mfma_f32_16x16x32_bf16 v[144:147], v[208:211], v[176:179], v[144:147]
    ds_read_b64_tr_b16 v[204:205], v238 offset:9248
    ds_read_b64_tr_b16 v[206:207], v238 offset:11552
    v_mfma_f32_16x16x32_bf16 v[148:151], v[208:211], v[180:183], v[148:151]
    v_mfma_f32_16x16x32_bf16 v[152:155], v[208:211], v[184:187], v[152:155]
    s_add_u32 m0, m0, 1024
    s_add_u32 s58, s58, 9216
    buffer_load_dwordx4 v244, s[20:23], s58 offen lds
    v_mfma_f32_16x16x32_bf16 v[156:159], v[208:211], v[188:191], v[156:159]
    s_cmp_lg_u32 s43, 1
    s_cbranch_scc1 K1_P0_1_9
    v_mfma_f32_16x16x32_bf16 v[220:223], v[208:211], v[224:227], v[220:223]
K1_P0_1_9:
    s_mov_b32 s57, s52
    s_mov_b32 s52, s53
    s_mov_b32 s53, s57
    s_mov_b32 s57, s51
    s_mov_b32 s51, s59
    s_mov_b32 s59, s57
    s_add_u32 s50, s50, 1
    s_branch K1_HOOK0
.p2align 6
K1_LOOP0:
    s_waitcnt lgkmcnt(6)
    v_mfma_f32_16x16x32_bf16 v[0:3], v[192:195], v[160:163], v[0:3]
    ds_read_b64_tr_b16 v[208:209], v238 offset:64
    ds_read_b64_tr_b16 v[210:211], v238 offset:2368
    v_mfma_f32_16x16x32_bf16 v[4:7], v[192:195], v[164:167], v[4:7]
    v_mfma_f32_16x16x32_bf16 v[8:11], v[192:195], v[168:171], v[8:11]
    v_mfma_f32_16x16x32_bf16 v[12:15], v[192:195], v[172:175], v[12:15]
    s_waitcnt lgkmcnt(6)
    v_mfma_f32_16x16x32_bf16 v[16:19], v[196:199], v[160:163], v[16:19]
    ds_read_b64_tr_b16 v[192:193], v238 offset:9280
    ds_read_b64_tr_b16 v[194:195], v238 offset:11584
    v_mfma_f32_16x16x32_bf16 v[20:23], v[196:199], v[164:167], v[20:23]
    v_mfma_f32_16x16x32_bf16 v[24:27], v[196:199], v[168:171], v[24:27]
    v_mfma_f32_16x16x32_bf16 v[28:31], v[196:199], v[172:175], v[28:31]
    s_waitcnt vmcnt(7)
    s_barrier
    s_waitcnt lgkmcnt(6)
    v_mfma_f32_16x16x32_bf16 v[32:35], v[200:203], v[160:163], v[32:35]
    ds_read_b64_tr_b16 v[196:197], v238 offset:96
    ds_read_b64_tr_b16 v[198:199], v238 offset:2400
    v_mfma_f32_16x16x32_bf16 v[36:39], v[200:203], v[164:167], v[36:39]
    ds_read_b128 v[176:179], v237 offset:0
    v_mfma_f32_16x16x32_bf16 v[40:43], v[200:203], v[168:171], v[40:43]
    s_mul_i32 s46, s3, 294912
    s_add_u32 s57, s53, s54
    s_add_u32 m0, s57, 23552
    s_add_u32 s46, s46, s61
    buffer_load_dwordx4 v241, s[24:27], s46 offen lds
    v_mfma_f32_16x16x32_bf16 v[44:47], v[200:203], v[172:175], v[44:47]
    s_waitcnt lgkmcnt(7)
    v_mfma_f32_16x16x32_bf16 v[48:51], v[204:207], v[160:163], v[48:51]
    ds_read_b64_tr_b16 v[200:201], v238 offset:9312
    ds_read_b64_tr_b16 v[202:203], v238 offset:11616
    v_mfma_f32_16x16x32_bf16 v[52:55], v[204:207], v[164:167], v[52:55]
    ds_read_b128 v[180:183], v237 offset:2048
    v_mfma_f32_16x16x32_bf16 v[56:59], v[204:207], v[168:171], v[56:59]
    s_add_u32 m0, s57, 32768
    s_mul_i32 s47, s3, s48
    buffer_load_dwordx4 v241, s[28:31], s46 offen lds
    s_add_u32 s47, s47, s62
    v_mfma_f32_16x16x32_bf16 v[60:63], v[204:207], v[172:175], v[60:63]
    s_waitcnt lgkmcnt(8)
    v_mfma_f32_16x16x32_bf16 v[64:67], v[208:211], v[160:163], v[64:67]
    ds_read_b64_tr_b16 v[204:205], v238 offset:128
    ds_read_b64_tr_b16 v[206:207], v238 offset:2432
    v_mfma_f32_16x16x32_bf16 v[68:71], v[208:211], v[164:167], v[68:71]
    ds_read_b128 v[184:187], v237 offset:4096
    v_mfma_f32_16x16x32_bf16 v[72:75], v[208:211], v[168:171], v[72:75]
    s_add_u32 s57, s53, s49
    s_add_u32 m0, s57, 23552
    s_add_u32 s3, s3, 1
    buffer_load_dwordx4 v242, s[32:35], s47 offen lds
    s_cmp_eq_u32 s3, 18
    s_cselect_b32 s3, 0, s3
    s_cmp_eq_u32 s3, s18
    s_cselect_b32 s3, 64, s3
    v_mfma_f32_16x16x32_bf16 v[76:79], v[208:211], v[172:175], v[76:79]
    s_waitcnt lgkmcnt(9)
    v_mfma_f32_16x16x32_bf16 v[80:83], v[192:195], v[160:163], v[80:83]
    ds_read_b64_tr_b16 v[208:209], v238 offset:9344
    ds_read_b64_tr_b16 v[210:211], v238 offset:11648
    v_mfma_f32_16x16x32_bf16 v[84:87], v[192:195], v[164:167], v[84:87]
    ds_read_b128 v[188:191], v237 offset:6144
    v_mfma_f32_16x16x32_bf16 v[88:91], v[192:195], v[168:171], v[88:91]
    s_cmp_lg_u32 s16, 0
    s_cbranch_scc1 K1_HOOKS
K1_HRET0:
    v_mfma_f32_16x16x32_bf16 v[92:95], v[192:195], v[172:175], v[92:95]
    s_waitcnt lgkmcnt(10)
    v_mfma_f32_16x16x32_bf16 v[96:99], v[196:199], v[160:163], v[96:99]
    ds_read_b64_tr_b16 v[192:193], v238 offset:23552
    ds_read_b64_tr_b16 v[194:195], v238 offset:25856
    v_mfma_f32_16x16x32_bf16 v[100:103], v[196:199], v[164:167], v[100:103]
    v_mfma_f32_16x16x32_bf16 v[104:107], v[196:199], v[168:171], v[104:107]
    v_mfma_f32_16x16x32_bf16 v[108:111], v[196:199], v[172:175], v[108:111]
    v_add_u32 v237, s51, v237
    s_waitcnt lgkmcnt(9)
    v_mfma_f32_16x16x32_bf16 v[112:115], v[200:203], v[160:163], v[112:115]
    ds_read_b64_tr_b16 v[196:197], v238 offset:32768
    ds_read_b64_tr_b16 v[198:199], v238 offset:35072
    v_mfma_f32_16x16x32_bf16 v[116:119], v[200:203], v[164:167], v[116:119]
    v_mfma_f32_16x16x32_bf16 v[120:123], v[200:203], v[168:171], v[120:123]
    v_mfma_f32_16x16x32_bf16 v[124:127], v[200:203], v[172:175], v[124:127]
    s_waitcnt lgkmcnt(8)
    v_mfma_f32_16x16x32_bf16 v[128:131], v[204:207], v[160:163], v[128:131]
    ds_read_b64_tr_b16 v[200:201], v238 offset:23584
    ds_read_b64_tr_b16 v[202:203], v238 offset:25888
    v_mfma_f32_16x16x32_bf16 v[132:135], v[204:207], v[164:167], v[132:135]
    v_mfma_f32_16x16x32_bf16 v[136:139], v[204:207], v[168:171], v[136:139]
    v_mfma_f32_16x16x32_bf16 v[140:143], v[204:207], v[172:175], v[140:143]
    s_waitcnt lgkmcnt(7)
    v_mfma_f32_16x16x32_bf16 v[144:147], v[208:211], v[160:163], v[144:147]
    ds_read_b64_tr_b16 v[204:205], v238 offset:32800
    ds_read_b64_tr_b16 v[206:207], v238 offset:35104
    v_mfma_f32_16x16x32_bf16 v[148:151], v[208:211], v[164:167], v[148:151]
    v_mfma_f32_16x16x32_bf16 v[152:155], v[208:211], v[168:171], v[152:155]
    v_mfma_f32_16x16x32_bf16 v[156:159], v[208:211], v[172:175], v[156:159]
    s_waitcnt lgkmcnt(6)
    v_mfma_f32_16x16x32_bf16 v[0:3], v[192:195], v[176:179], v[0:3]
    ds_read_b64_tr_b16 v[208:209], v238 offset:23616
    ds_read_b64_tr_b16 v[210:211], v238 offset:25920
    v_mfma_f32_16x16x32_bf16 v[4:7], v[192:195], v[180:183], v[4:7]
    v_mfma_f32_16x16x32_bf16 v[8:11], v[192:195], v[184:187], v[8:11]
    v_mfma_f32_16x16x32_bf16 v[12:15], v[192:195], v[188:191], v[12:15]
    s_waitcnt lgkmcnt(6)
    v_mfma_f32_16x16x32_bf16 v[16:19], v[196:199], v[176:179], v[16:19]
    ds_read_b64_tr_b16 v[192:193], v238 offset:32832
    ds_read_b64_tr_b16 v[194:195], v238 offset:35136
    v_mfma_f32_16x16x32_bf16 v[20:23], v[196:199], v[180:183], v[20:23]
    v_mfma_f32_16x16x32_bf16 v[24:27], v[196:199], v[184:187], v[24:27]
    v_mfma_f32_16x16x32_bf16 v[28:31], v[196:199], v[188:191], v[28:31]
    s_cmp_lg_u32 s16, 0
    s_cbranch_scc1 K1_NOW0
    s_waitcnt vmcnt(3)
    s_branch K1_W20
K1_NOW0:
    s_waitcnt vmcnt(6)
K1_W20:
    s_barrier
    s_waitcnt lgkmcnt(6)
    v_mfma_f32_16x16x32_bf16 v[32:35], v[200:203], v[176:179], v[32:35]
    ds_read_b64_tr_b16 v[196:197], v238 offset:23648
    ds_read_b64_tr_b16 v[198:199], v238 offset:25952
    v_mfma_f32_16x16x32_bf16 v[36:39], v[200:203], v[180:183], v[36:39]
    ds_read_b128 v[160:163], v236 offset:0
    v_mfma_f32_16x16x32_bf16 v[40:43], v[200:203], v[184:187], v[40:43]
    s_mul_i32 s46, s3, 294912
    s_add_u32 s57, s52, s54
    s_add_u32 m0, s57, 0
    s_add_u32 s46, s46, s61
    buffer_load_dwordx4 v241, s[24:27], s46 offen lds
    v_mfma_f32_16x16x32_bf16 v[44:47], v[200:203], v[188:191], v[44:47]
    s_waitcnt lgkmcnt(7)
    v_mfma_f32_16x16x32_bf16 v[48:51], v[204:207], v[176:179], v[48:51]
    ds_read_b64_tr_b16 v[200:201], v238 offset:32864
    ds_read_b64_tr_b16 v[202:203], v238 offset:35168
    v_mfma_f32_16x16x32_bf16 v[52:55], v[204:207], v[180:183], v[52:55]
    ds_read_b128 v[164:167], v236 offset:2048
    v_mfma_f32_16x16x32_bf16 v[56:59], v[204:207], v[184:187], v[56:59]
    s_add_u32 m0, s57, 9216
    s_mul_i32 s47, s3, s48
    buffer_load_dwordx4 v241, s[28:31], s46 offen lds
    s_add_u32 s47, s47, s62
    v_mfma_f32_16x16x32_bf16 v[60:63], v[204:207], v[188:191], v[60:63]
    s_waitcnt lgkmcnt(8)
    v_mfma_f32_16x16x32_bf16 v[64:67], v[208:211], v[176:179], v[64:67]
    ds_read_b64_tr_b16 v[204:205], v238 offset:23680
    ds_read_b64_tr_b16 v[206:207], v238 offset:25984
    v_mfma_f32_16x16x32_bf16 v[68:71], v[208:211], v[180:183], v[68:71]
    ds_read_b128 v[168:171], v236 offset:4096
    v_mfma_f32_16x16x32_bf16 v[72:75], v[208:211], v[184:187], v[72:75]
    s_add_u32 s57, s52, s49
    s_add_u32 m0, s57, 0
    s_add_u32 s3, s3, 1
    buffer_load_dwordx4 v242, s[32:35], s47 offen lds
    s_cmp_eq_u32 s3, 18
    s_cselect_b32 s3, 0, s3
    s_cmp_eq_u32 s3, s18
    s_cselect_b32 s3, 64, s3
    v_mfma_f32_16x16x32_bf16 v[76:79], v[208:211], v[188:191], v[76:79]
    s_waitcnt lgkmcnt(9)
    v_mfma_f32_16x16x32_bf16 v[80:83], v[192:195], v[176:179], v[80:83]
    ds_read_b64_tr_b16 v[208:209], v238 offset:32896
    ds_read_b64_tr_b16 v[210:211], v238 offset:35200
    v_mfma_f32_16x16x32_bf16 v[84:87], v[192:195], v[180:183], v[84:87]
    ds_read_b128 v[172:175], v236 offset:6144
    v_mfma_f32_16x16x32_bf16 v[88:91], v[192:195], v[184:187], v[88:91]
    s_lshl_b32 s58, s19, 7
    s_add_u32 s58, s58, s45
    s_add_u32 s19, s19, 1
    s_cmp_eq_u32 s19, 9
    s_cselect_b32 s19, 0, s19
    s_cmp_eq_u32 s19, s60
    s_cselect_b32 s19, 0x800000, s19
    v_mfma_f32_16x16x32_bf16 v[92:95], v[192:195], v[188:191], v[92:95]
    s_waitcnt lgkmcnt(10)
    v_add_u32 v238, s51, v238
    v_mfma_f32_16x16x32_bf16 v[96:99], v[196:199], v[176:179], v[96:99]
    ds_read_b64_tr_b16 v[192:193], v238 offset:0
    ds_read_b64_tr_b16 v[194:195], v238 offset:2304
    v_mfma_f32_16x16x32_bf16 v[100:103], v[196:199], v[180:183], v[100:103]
    v_mfma_f32_16x16x32_bf16 v[104:107], v[196:199], v[184:187], v[104:107]
    s_add_u32 m0, s52, s55
    s_nop 0
    buffer_load_dwordx4 v243, s[20:23], s58 offen lds
    v_mfma_f32_16x16x32_bf16 v[108:111], v[196:199], v[188:191], v[108:111]
    v_add_u32 v236, s59, v236
    s_waitcnt lgkmcnt(9)
    v_mfma_f32_16x16x32_bf16 v[112:115], v[200:203], v[176:179], v[112:115]
    ds_read_b64_tr_b16 v[196:197], v238 offset:9216
    ds_read_b64_tr_b16 v[198:199], v238 offset:11520
    v_mfma_f32_16x16x32_bf16 v[116:119], v[200:203], v[180:183], v[116:119]
    v_mfma_f32_16x16x32_bf16 v[120:123], v[200:203], v[184:187], v[120:123]
    s_add_u32 m0, m0, 1024
    s_add_u32 s58, s58, 9216
    buffer_load_dwordx4 v244, s[20:23], s58 offen lds
    v_mfma_f32_16x16x32_bf16 v[124:127], v[200:203], v[188:191], v[124:127]
    s_waitcnt lgkmcnt(8)
    v_mfma_f32_16x16x32_bf16 v[128:131], v[204:207], v[176:179], v[128:131]
    ds_read_b64_tr_b16 v[200:201], v238 offset:32
    ds_read_b64_tr_b16 v[202:203], v238 offset:2336
    v_mfma_f32_16x16x32_bf16 v[132:135], v[204:207], v[180:183], v[132:135]
    v_mfma_f32_16x16x32_bf16 v[136:139], v[204:207], v[184:187], v[136:139]
    s_add_u32 m0, m0, 1024
    s_add_u32 s58, s58, 9216
    buffer_load_dwordx4 v243, s[20:23], s58 offen lds
    v_mfma_f32_16x16x32_bf16 v[140:143], v[204:207], v[188:191], v[140:143]
    s_waitcnt lgkmcnt(7)
    v_mfma_f32_16x16x32_bf16 v[144:147], v[208:211], v[176:179], v[144:147]
    ds_read_b64_tr_b16 v[204:205], v238 offset:9248
    ds_read_b64_tr_b16 v[206:207], v238 offset:11552
    v_mfma_f32_16x16x32_bf16 v[148:151], v[208:211], v[180:183], v[148:151]
    v_mfma_f32_16x16x32_bf16 v[152:155], v[208:211], v[184:187], v[152:155]
    s_add_u32 m0, m0, 1024
    s_add_u32 s58, s58, 9216
    buffer_load_dwordx4 v244, s[20:23], s58 offen lds
    v_mfma_f32_16x16x32_bf16 v[156:159], v[208:211], v[188:191], v[156:159]
    s_mov_b32 s57, s52
    s_mov_b32 s52, s53
    s_mov_b32 s53, s57
    s_mov_b32 s57, s51
    s_mov_b32 s51, s59
    s_mov_b32 s59, s57
    s_add_u32 s50, s50, 1
K1_HOOK0:
    s_lshl_b32 s16, 1, s50
    s_and_b32 s57, s16, s101
    s_cbranch_scc1 K1_PROD0
    s_and_b32 s16, s16, s17
    s_cmp_lt_u32 s50, 8
    s_cbranch_scc1 K1_LOOP0
    v_and_b32 v251, 15, v255
    v_lshlrev_b32 v251, 4, v251
    v_lshlrev_b32 v252, 2, v255
    s_lshl_b32 s63, s41, 12
    s_lshl_b32 s58, s43, 10
    s_add_u32 s63, s63, s58
    s_add_u32 s63, s63, 44040192
    s_mul_i32 s47, s40, 10240
    s_lshl_b32 s58, s42, 8
    s_add_u32 s47, s47, s58
    s_add_u32 s47, s47, 44105728
    s_cmp_ge_u32 s42, 5
    s_cselect_b32 s47, 0x70000000, s47
    s_waitcnt vmcnt(7)
    s_barrier
    v_cmp_ne_u32 vcc, 0x01010101, v245
    s_nop 4
    s_cmp_eq_u64 vcc, 0
    s_cbranch_scc1 K1_LGO0
    v_mov_b32 v246, 81152
    v_mov_b32 v247, 1
    s_mov_b32 s63, 0x70000000
    s_mov_b32 s47, 0x70000000
    s_waitcnt lgkmcnt(0)
    ds_write_b32 v246, v247
    s_waitcnt lgkmcnt(0)
K1_LGO0:
    s_waitcnt lgkmcnt(6)
    v_mfma_f32_16x16x32_bf16 v[0:3], v[192:195], v[160:163], v[0:3]
    ds_read_b64_tr_b16 v[208:209], v238 offset:64
    ds_read_b64_tr_b16 v[210:211], v238 offset:2368
    v_mfma_f32_16x16x32_bf16 v[4:7], v[192:195], v[164:167], v[4:7]
    v_mfma_f32_16x16x32_bf16 v[8:11], v[192:195], v[168:171], v[8:11]
    v_mfma_f32_16x16x32_bf16 v[12:15], v[192:195], v[172:175], v[12:15]
    s_waitcnt lgkmcnt(6)
    v_mfma_f32_16x16x32_bf16 v[16:19], v[196:199], v[160:163], v[16:19]
    ds_read_b64_tr_b16 v[192:193], v238 offset:9280
    ds_read_b64_tr_b16 v[194:195], v238 offset:11584
    v_mfma_f32_16x16x32_bf16 v[20:23], v[196:199], v[164:167], v[20:23]
    v_mfma_f32_16x16x32_bf16 v[24:27], v[196:199], v[168:171], v[24:27]
    v_mfma_f32_16x16x32_bf16 v[28:31], v[196:199], v[172:175], v[28:31]
    s_waitcnt lgkmcnt(6)
    v_mfma_f32_16x16x32_bf16 v[32:35], v[200:203], v[160:163], v[32:35]
    ds_read_b64_tr_b16 v[196:197], v238 offset:96
    ds_read_b64_tr_b16 v[198:199], v238 offset:2400
    v_mfma_f32_16x16x32_bf16 v[36:39], v[200:203], v[164:167], v[36:39]
    ds_read_b128 v[176:179], v237 offset:0
    v_mfma_f32_16x16x32_bf16 v[40:43], v[200:203], v[168:171], v[40:43]
    buffer_load_dwordx4 v[212:215], v251, s[36:39], s63 offen offset:0 sc1
    buffer_load_dwordx4 v[216:219], v251, s[36:39], s63 offen offset:256 sc1
    v_mfma_f32_16x16x32_bf16 v[44:47], v[200:203], v[172:175], v[44:47]
    s_waitcnt lgkmcnt(7)
    v_mfma_f32_16x16x32_bf16 v[48:51], v[204:207], v[160:163], v[48:51]
    ds_read_b64_tr_b16 v[200:201], v238 offset:9312
    ds_read_b64_tr_b16 v[202:203], v238 offset:11616
    v_mfma_f32_16x16x32_bf16 v[52:55], v[204:207], v[164:167], v[52:55]
    ds_read_b128 v[180:183], v237 offset:2048
    v_mfma_f32_16x16x32_bf16 v[56:59], v[204:207], v[168:171], v[56:59]
    buffer_load_dwordx4 v[220:223], v251, s[36:39], s63 offen offset:512 sc1
    buffer_load_dwordx4 v[224:227], v251, s[36:39], s63 offen offset:768 sc1
    v_mfma_f32_16x16x32_bf16 v[60:63], v[204:207], v[172:175], v[60:63]
    s_waitcnt lgkmcnt(8)
    v_mfma_f32_16x16x32_bf16 v[64:67], v[208:211], v[160:163], v[64:67]
    ds_read_b64_tr_b16 v[204:205], v238 offset:128
    ds_read_b64_tr_b16 v[206:207], v238 offset:2432
    v_mfma_f32_16x16x32_bf16 v[68:71], v[208:211], v[164:167], v[68:71]
    ds_read_b128 v[184:187], v237 offset:4096
    v_mfma_f32_16x16x32_bf16 v[72:75], v[208:211], v[168:171], v[72:75]
    buffer_load_dword v228, v252, s[36:39], s47 offen offset:0 sc1
    buffer_load_dword v229, v252, s[36:39], s47 offen offset:1280 sc1
    v_mfma_f32_16x16x32_bf16 v[76:79], v[208:211], v[172:175], v[76:79]
    s_waitcnt lgkmcnt(9)
    v_mfma_f32_16x16x32_bf16 v[80:83], v[192:195], v[160:163], v[80:83]
    ds_read_b64_tr_b16 v[208:209], v238 offset:9344
    ds_read_b64_tr_b16 v[210:211], v238 offset:11648
    v_mfma_f32_16x16x32_bf16 v[84:87], v[192:195], v[164:167], v[84:87]
    ds_read_b128 v[188:191], v237 offset:6144
    v_mfma_f32_16x16x32_bf16 v[88:91], v[192:195], v[168:171], v[88:91]
    buffer_load_dword v230, v252, s[36:39], s47 offen offset:2560 sc1
    s_add_u32 s47, s47, 3840
    buffer_load_dword v231, v252, s[36:39], s47 offen offset:0 sc1
    v_mfma_f32_16x16x32_bf16 v[92:95], v[192:195], v[172:175], v[92:95]
    s_waitcnt lgkmcnt(10)
    v_mfma_f32_16x16x32_bf16 v[96:99], v[196:199], v[160:163], v[96:99]
    ds_read_b64_tr_b16 v[192:193], v238 offset:23552
    ds_read_b64_tr_b16 v[194:195], v238 offset:25856
    v_mfma_f32_16x16x32_bf16 v[100:103], v[196:199], v[164:167], v[100:103]
    v_mfma_f32_16x16x32_bf16 v[104:107], v[196:199], v[168:171], v[104:107]
    buffer_load_dword v232, v252, s[36:39], s47 offen offset:1280 sc1
    buffer_load_dword v233, v252, s[36:39], s47 offen offset:2560 sc1
    v_mfma_f32_16x16x32_bf16 v[108:111], v[196:199], v[172:175], v[108:111]
    v_add_u32 v237, s51, v237
    s_waitcnt lgkmcnt(9)
    v_mfma_f32_16x16x32_bf16 v[112:115], v[200:203], v[160:163], v[112:115]
    ds_read_b64_tr_b16 v[196:197], v238 offset:32768
    ds_read_b64_tr_b16 v[198:199], v238 offset:35072
    v_mfma_f32_16x16x32_bf16 v[116:119], v[200:203], v[164:167], v[116:119]
    v_mfma_f32_16x16x32_bf16 v[120:123], v[200:203], v[168:171], v[120:123]
    s_add_u32 s47, s47, 3840
    buffer_load_dword v234, v252, s[36:39], s47 offen offset:0 sc1
    buffer_load_dword v235, v252, s[36:39], s47 offen offset:1280 sc1
    v_mfma_f32_16x16x32_bf16 v[124:127], v[200:203], v[172:175], v[124:127]
    s_waitcnt lgkmcnt(8)
    v_mfma_f32_16x16x32_bf16 v[128:131], v[204:207], v[160:163], v[128:131]
    ds_read_b64_tr_b16 v[200:201], v238 offset:23584
    ds_read_b64_tr_b16 v[202:203], v238 offset:25888
    v_mfma_f32_16x16x32_bf16 v[132:135], v[204:207], v[164:167], v[132:135]
    v_mfma_f32_16x16x32_bf16 v[136:139], v[204:207], v[168:171], v[136:139]
    v_mfma_f32_16x16x32_bf16 v[140:143], v[204:207], v[172:175], v[140:143]
    s_waitcnt lgkmcnt(7)
    v_mfma_f32_16x16x32_bf16 v[144:147], v[208:211], v[160:163], v[144:147]
    ds_read_b64_tr_b16 v[204:205], v238 offset:32800
    ds_read_b64_tr_b16 v[206:207], v238 offset:35104
    v_mfma_f32_16x16x32_bf16 v[148:151], v[208:211], v[164:167], v[148:151]
    v_mfma_f32_16x16x32_bf16 v[152:155], v[208:211], v[168:171], v[152:155]
    v_mfma_f32_16x16x32_bf16 v[156:159], v[208:211], v[172:175], v[156:159]
    s_waitcnt lgkmcnt(6)
    v_mfma_f32_16x16x32_bf16 v[0:3], v[192:195], v[176:179], v[0:3]
    ds_read_b64_tr_b16 v[208:209], v238 offset:23616
    ds_read_b64_tr_b16 v[210:211], v238 offset:25920
    v_mfma_f32_16x16x32_bf16 v[4:7], v[192:195], v[180:183], v[4:7]
    v_mfma_f32_16x16x32_bf16 v[8:11], v[192:195], v[184:187], v[8:11]
    v_mfma_f32_16x16x32_bf16 v[12:15], v[192:195], v[188:191], v[12:15]
    s_waitcnt lgkmcnt(6)
    v_mfma_f32_16x16x32_bf16 v[16:19], v[196:199], v[176:179], v[16:19]
    ds_read_b64_tr_b16 v[192:193], v238 offset:32832
    ds_read_b64_tr_b16 v[194:195], v238 offset:35136
    v_mfma_f32_16x16x32_bf16 v[20:23], v[196:199], v[180:183], v[20:23]
    v_mfma_f32_16x16x32_bf16 v[24:27], v[196:199], v[184:187], v[24:27]
    v_mfma_f32_16x16x32_bf16 v[28:31], v[196:199], v[188:191], v[28:31]
    s_waitcnt lgkmcnt(6)
    v_mfma_f32_16x16x32_bf16 v[32:35], v[200:203], v[176:179], v[32:35]
    ds_read_b64_tr_b16 v[196:197], v238 offset:23648
    ds_read_b64_tr_b16 v[198:199], v238 offset:25952
    v_mfma_f32_16x16x32_bf16 v[36:39], v[200:203], v[180:183], v[36:39]
    v_mfma_f32_16x16x32_bf16 v[40:43], v[200:203], v[184:187], v[40:43]
    v_mfma_f32_16x16x32_bf16 v[44:47], v[200:203], v[188:191], v[44:47]
    s_waitcnt lgkmcnt(6)
    v_mfma_f32_16x16x32_bf16 v[48:51], v[204:207], v[176:179], v[48:51]
    ds_read_b64_tr_b16 v[200:201], v238 offset:32864
    ds_read_b64_tr_b16 v[202:203], v238 offset:35168
    v_mfma_f32_16x16x32_bf16 v[52:55], v[204:207], v[180:183], v[52:55]
    v_mfma_f32_16x16x32_bf16 v[56:59], v[204:207], v[184:187], v[56:59]
    v_mfma_f32_16x16x32_bf16 v[60:63], v[204:207], v[188:191], v[60:63]
    s_waitcnt lgkmcnt(6)
    v_mfma_f32_16x16x32_bf16 v[64:67], v[208:211], v[176:179], v[64:67]
    ds_read_b64_tr_b16 v[204:205], v238 offset:23680
    ds_read_b64_tr_b16 v[206:207], v238 offset:25984
    v_mfma_f32_16x16x32_bf16 v[68:71], v[208:211], v[180:183], v[68:71]
    v_mfma_f32_16x16x32_bf16 v[72:75], v[208:211], v[184:187], v[72:75]
    v_mfma_f32_16x16x32_bf16 v[76:79], v[208:211], v[188:191], v[76:79]
    s_waitcnt lgkmcnt(6)
    v_mfma_f32_16x16x32_bf16 v[80:83], v[192:195], v[176:179], v[80:83]
    ds_read_b64_tr_b16 v[208:209], v238 offset:32896
    ds_read_b64_tr_b16 v[210:211], v238 offset:35200
    v_mfma_f32_16x16x32_bf16 v[84:87], v[192:195], v[180:183], v[84:87]
    v_mfma_f32_16x16x32_bf16 v[88:91], v[192:195], v[184:187], v[88:91]
    v_mfma_f32_16x16x32_bf16 v[92:95], v[192:195], v[188:191], v[92:95]
    s_waitcnt lgkmcnt(6)
    v_add_u32 v238, s51, v238
    v_mfma_f32_16x16x32_bf16 v[96:99], v[196:199], v[176:179], v[96:99]
    v_mfma_f32_16x16x32_bf16 v[100:103], v[196:199], v[180:183], v[100:103]
    v_mfma_f32_16x16x32_bf16 v[104:107], v[196:199], v[184:187], v[104:107]
    v_mfma_f32_16x16x32_bf16 v[108:111], v[196:199], v[188:191], v[108:111]
    v_add_u32 v236, s59, v236
    s_waitcnt lgkmcnt(4)
    s_waitcnt vmcnt(0)
    v_add_f32 v228, v228, v232
    v_add_f32 v229, v229, v233
    v_add_f32 v230, v230, v234
    v_add_f32 v231, v231, v235
    v_add_f32 v228, v228, v229
    v_add_f32 v230, v230, v231
    s_lshl_b32 s57, s42, 8
    s_add_u32 s57, s57, 79872
    v_add_f32 v228, v228, v230
    v_lshl_add_u32 v246, v255, 2, s57
    ds_write_b32 v246, v228
    s_waitcnt lgkmcnt(0)
    s_barrier
    v_mfma_f32_16x16x32_bf16 v[112:115], v[200:203], v[176:179], v[112:115]
    v_mfma_f32_16x16x32_bf16 v[116:119], v[200:203], v[180:183], v[116:119]
    v_mfma_f32_16x16x32_bf16 v[120:123], v[200:203], v[184:187], v[120:123]
    v_mfma_f32_16x16x32_bf16 v[124:127], v[200:203], v[188:191], v[124:127]
    v_mfma_f32_16x16x32_bf16 v[128:131], v[204:207], v[176:179], v[128:131]
    v_mfma_f32_16x16x32_bf16 v[132:135], v[204:207], v[180:183], v[132:135]
    v_mfma_f32_16x16x32_bf16 v[136:139], v[204:207], v[184:187], v[136:139]
    v_mfma_f32_16x16x32_bf16 v[140:143], v[204:207], v[188:191], v[140:143]
    v_mfma_f32_16x16x32_bf16 v[144:147], v[208:211], v[176:179], v[144:147]
    v_mfma_f32_16x16x32_bf16 v[148:151], v[208:211], v[180:183], v[148:151]
    v_mfma_f32_16x16x32_bf16 v[152:155], v[208:211], v[184:187], v[152:155]
    v_mfma_f32_16x16x32_bf16 v[156:159], v[208:211], v[188:191], v[156:159]
    s_mov_b32 s57, s52
    s_mov_b32 s52, s53
    s_mov_b32 s53, s57
    s_mov_b32 s57, s51
    s_mov_b32 s51, s59
    s_mov_b32 s59, s57
    s_add_u32 s50, s50, 1
    s_branch K1_EPI
K1_PROD1:
    s_waitcnt lgkmcnt(6)
    v_mfma_f32_16x16x32_bf16 v[0:3], v[192:195], v[160:163], v[0:3]
    ds_read_b64_tr_b16 v[208:209], v238 offset:64
    ds_read_b64_tr_b16 v[210:211], v238 offset:2368
    v_mfma_f32_16x16x32_bf16 v[4:7], v[192:195], v[164:167], v[4:7]
    v_mfma_f32_16x16x32_bf16 v[8:11], v[192:195], v[168:171], v[8:11]
    v_mfma_f32_16x16x32_bf16 v[12:15], v[192:195], v[172:175], v[12:15]
    s_cmp_lg_u32 s43, 0
    s_cbranch_scc1 K1_P1_0_0
    v_mfma_f32_16x16x32_bf16 v[212:215], v[192:195], v[224:227], v[212:215]
K1_P1_0_0:
    s_waitcnt lgkmcnt(6)
    v_mfma_f32_16x16x32_bf16 v[16:19], v[196:199], v[160:163], v[16:19]
    ds_read_b64_tr_b16 v[192:193], v238 offset:9280
    ds_read_b64_tr_b16 v[194:195], v238 offset:11584
    v_mfma_f32_16x16x32_bf16 v[20:23], v[196:199], v[164:167], v[20:23]
    v_mfma_f32_16x16x32_bf16 v[24:27], v[196:199], v[168:171], v[24:27]
    v_mfma_f32_16x16x32_bf16 v[28:31], v[196:199], v[172:175], v[28:31]
    s_cmp_lg_u32 s43, 1
    s_cbranch_scc1 K1_P1_0_1
    v_mfma_f32_16x16x32_bf16 v[212:215], v[196:199], v[224:227], v[212:215]
K1_P1_0_1:
    s_waitcnt vmcnt(7)
    s_barrier
    s_waitcnt lgkmcnt(6)
    v_mfma_f32_16x16x32_bf16 v[32:35], v[200:203], v[160:163], v[32:35]
    ds_read_b64_tr_b16 v[196:197], v238 offset:96
    ds_read_b64_tr_b16 v[198:199], v238 offset:2400
    v_mfma_f32_16x16x32_bf16 v[36:39], v[200:203], v[164:167], v[36:39]
    ds_read_b128 v[176:179], v237 offset:0
    v_mfma_f32_16x16x32_bf16 v[40:43], v[200:203], v[168:171], v[40:43]
    s_mul_i32 s46, s3, 294912
    s_add_u32 s57, s53, s54
    s_add_u32 m0, s57, 23552
    s_add_u32 s46, s46, s61
    buffer_load_dwordx4 v241, s[24:27], s46 offen lds
    v_mfma_f32_16x16x32_bf16 v[44:47], v[200:203], v[172:175], v[44:47]
    s_cmp_lg_u32 s43, 2
    s_cbranch_scc1 K1_P1_0_2
    v_mfma_f32_16x16x32_bf16 v[212:215], v[200:203], v[224:227], v[212:215]
K1_P1_0_2:
    s_waitcnt lgkmcnt(7)
    v_mfma_f32_16x16x32_bf16 v[48:51], v[204:207], v[160:163], v[48:51]
    ds_read_b64_tr_b16 v[200:201], v238 offset:9312
    ds_read_b64_tr_b16 v[202:203], v238 offset:11616
    v_mfma_f32_16x16x32_bf16 v[52:55], v[204:207], v[164:167], v[52:55]
    ds_read_b128 v[180:183], v237 offset:2048
    v_mfma_f32_16x16x32_bf16 v[56:59], v[204:207], v[168:171], v[56:59]
    s_add_u32 m0, s57, 32768
    s_mul_i32 s47, s3, s48
    buffer_load_dwordx4 v241, s[28:31], s46 offen lds
    s_add_u32 s47, s47, s62
    v_mfma_f32_16x16x32_bf16 v[60:63], v[204:207], v[172:175], v[60:63]
    s_cmp_lg_u32 s43, 3
    s_cbranch_scc1 K1_P1_0_3
    v_mfma_f32_16x16x32_bf16 v[212:215], v[204:207], v[224:227], v[212:215]
K1_P1_0_3:
    s_waitcnt lgkmcnt(8)
    v_mfma_f32_16x16x32_bf16 v[64:67], v[208:211], v[160:163], v[64:67]
    ds_read_b64_tr_b16 v[204:205], v239 offset:18432
    ds_read_b64_tr_b16 v[206:207], v239 offset:18944
    v_mfma_f32_16x16x32_bf16 v[68:71], v[208:211], v[164:167], v[68:71]
    ds_read_b128 v[184:187], v237 offset:4096
    v_mfma_f32_16x16x32_bf16 v[72:75], v[208:211], v[168:171], v[72:75]
    s_add_u32 s57, s53, s49
    s_add_u32 m0, s57, 23552
    s_add_u32 s3, s3, 1
    buffer_load_dwordx4 v242, s[32:35], s47 offen lds
    s_cmp_eq_u32 s3, 18
    s_cselect_b32 s3, 0, s3
    s_cmp_eq_u32 s3, s18
    s_cselect_b32 s3, 64, s3
    v_mfma_f32_16x16x32_bf16 v[76:79], v[208:211], v[172:175], v[76:79]
    s_cmp_lg_u32 s43, 0
    s_cbranch_scc1 K1_P1_0_4
    v_mfma_f32_16x16x32_bf16 v[216:219], v[208:211], v[224:227], v[216:219]
K1_P1_0_4:
    s_waitcnt lgkmcnt(9)
    v_mfma_f32_16x16x32_bf16 v[80:83], v[192:195], v[160:163], v[80:83]
    ds_read_b64_tr_b16 v[208:209], v240 offset:18432
    ds_read_b64_tr_b16 v[210:211], v240 offset:18944
    v_mfma_f32_16x16x32_bf16 v[84:87], v[192:195], v[164:167], v[84:87]
    ds_read_b128 v[188:191], v237 offset:6144
    v_mfma_f32_16x16x32_bf16 v[88:91], v[192:195], v[168:171], v[88:91]
    v_mfma_f32_16x16x32_bf16 v[92:95], v[192:195], v[172:175], v[92:95]
    s_cmp_lg_u32 s43, 1
    s_cbranch_scc1 K1_P1_0_5
    v_mfma_f32_16x16x32_bf16 v[216:219], v[192:195], v[224:227], v[216:219]
K1_P1_0_5:
    s_waitcnt lgkmcnt(10)
    v_mfma_f32_16x16x32_bf16 v[96:99], v[196:199], v[160:163], v[96:99]
    ds_read_b64_tr_b16 v[192:193], v238 offset:23552
    ds_read_b64_tr_b16 v[194:195], v238 offset:25856
    v_mfma_f32_16x16x32_bf16 v[100:103], v[196:199], v[164:167], v[100:103]
    v_mfma_f32_16x16x32_bf16 v[104:107], v[196:199], v[168:171], v[104:107]
    v_mfma_f32_16x16x32_bf16 v[108:111], v[196:199], v[172:175], v[108:111]
    v_add_u32 v237, s51, v237
    s_cmp_lg_u32 s43, 2
    s_cbranch_scc1 K1_P1_0_6
    v_mfma_f32_16x16x32_bf16 v[216:219], v[196:199], v[224:227], v[216:219]
K1_P1_0_6:
    s_waitcnt lgkmcnt(9)
    v_mfma_f32_16x16x32_bf16 v[112:115], v[200:203], v[160:163], v[112:115]
    ds_read_b64_tr_b16 v[196:197], v238 offset:32768
    ds_read_b64_tr_b16 v[198:199], v238 offset:35072
    v_mfma_f32_16x16x32_bf16 v[116:119], v[200:203], v[164:167], v[116:119]
    v_mfma_f32_16x16x32_bf16 v[120:123], v[200:203], v[168:171], v[120:123]
    v_mfma_f32_16x16x32_bf16 v[124:127], v[200:203], v[172:175], v[124:127]
    s_cmp_lg_u32 s43, 3
    s_cbranch_scc1 K1_P1_0_7
    v_mfma_f32_16x16x32_bf16 v[216:219], v[200:203], v[224:227], v[216:219]
K1_P1_0_7:
    s_waitcnt lgkmcnt(8)
    v_mfma_f32_16x16x32_bf16 v[128:131], v[204:207], v[160:163], v[128:131]
    ds_read_b64_tr_b16 v[200:201], v238 offset:23584
    ds_read_b64_tr_b16 v[202:203], v238 offset:25888
    v_mfma_f32_16x16x32_bf16 v[132:135], v[204:207], v[164:167], v[132:135]
    v_mfma_f32_16x16x32_bf16 v[136:139], v[204:207], v[168:171], v[136:139]
    v_mfma_f32_16x16x32_bf16 v[140:143], v[204:207], v[172:175], v[140:143]
    s_cmp_lg_u32 s43, 0
    s_cbranch_scc1 K1_P1_0_8
    v_mfma_f32_16x16x32_bf16 v[220:223], v[204:207], v[224:227], v[220:223]
K1_P1_0_8:
    s_waitcnt lgkmcnt(7)
    v_mfma_f32_16x16x32_bf16 v[144:147], v[208:211], v[160:163], v[144:147]
    ds_read_b64_tr_b16 v[204:205], v238 offset:32800
    ds_read_b64_tr_b16 v[206:207], v238 offset:35104
    v_mfma_f32_16x16x32_bf16 v[148:151], v[208:211], v[164:167], v[148:151]
    v_mfma_f32_16x16x32_bf16 v[152:155], v[208:211], v[168:171], v[152:155]
    v_mfma_f32_16x16x32_bf16 v[156:159], v[208:211], v[172:175], v[156:159]
    s_cmp_lg_u32 s43, 1
    s_cbranch_scc1 K1_P1_0_9
    v_mfma_f32_16x16x32_bf16 v[220:223], v[208:211], v[224:227], v[220:223]
K1_P1_0_9:
    s_waitcnt lgkmcnt(6)
    v_mfma_f32_16x16x32_bf16 v[0:3], v[192:195], v[176:179], v[0:3]
    ds_read_b64_tr_b16 v[208:209], v238 offset:23616
    ds_read_b64_tr_b16 v[210:211], v238 offset:25920
    v_mfma_f32_16x16x32_bf16 v[4:7], v[192:195], v[180:183], v[4:7]
    v_mfma_f32_16x16x32_bf16 v[8:11], v[192:195], v[184:187], v[8:11]
    v_mfma_f32_16x16x32_bf16 v[12:15], v[192:195], v[188:191], v[12:15]
    s_cmp_lg_u32 s43, 0
    s_cbranch_scc1 K1_P1_1_0
    v_mfma_f32_16x16x32_bf16 v[212:215], v[192:195], v[224:227], v[212:215]
K1_P1_1_0:
    s_waitcnt lgkmcnt(6)
    v_mfma_f32_16x16x32_bf16 v[16:19], v[196:199], v[176:179], v[16:19]
    ds_read_b64_tr_b16 v[192:193], v238 offset:32832
    ds_read_b64_tr_b16 v[194:195], v238 offset:35136
    v_mfma_f32_16x16x32_bf16 v[20:23], v[196:199], v[180:183], v[20:23]
    v_mfma_f32_16x16x32_bf16 v[24:27], v[196:199], v[184:187], v[24:27]
    v_mfma_f32_16x16x32_bf16 v[28:31], v[196:199], v[188:191], v[28:31]
    s_cmp_lg_u32 s43, 1
    s_cbranch_scc1 K1_P1_1_1
    v_mfma_f32_16x16x32_bf16 v[212:215], v[196:199], v[224:227], v[212:215]
K1_P1_1_1:
    s_waitcnt vmcnt(3)
    s_barrier
    s_waitcnt lgkmcnt(6)
    v_mfma_f32_16x16x32_bf16 v[32:35], v[200:203], v[176:179], v[32:35]
    ds_read_b64_tr_b16 v[196:197], v238 offset:23648
    ds_read_b64_tr_b16 v[198:199], v238 offset:25952
    v_mfma_f32_16x16x32_bf16 v[36:39], v[200:203], v[180:183], v[36:39]
    ds_read_b128 v[160:163], v236 offset:0
    v_mfma_f32_16x16x32_bf16 v[40:43], v[200:203], v[184:187], v[40:43]
    s_mul_i32 s46, s3, 294912
    s_add_u32 s57, s52, s54
    s_add_u32 m0, s57, 0
    s_add_u32 s46, s46, s61
    buffer_load_dwordx4 v241, s[24:27], s46 offen lds
    v_mfma_f32_16x16x32_bf16 v[44:47], v[200:203], v[188:191], v[44:47]
    s_cmp_lg_u32 s43, 2
    s_cbranch_scc1 K1_P1_1_2
    v_mfma_f32_16x16x32_bf16 v[212:215], v[200:203], v[224:227], v[212:215]
K1_P1_1_2:
    s_waitcnt lgkmcnt(7)
    v_mfma_f32_16x16x32_bf16 v[48:51], v[204:207], v[176:179], v[48:51]
    ds_read_b64_tr_b16 v[200:201], v238 offset:32864
    ds_read_b64_tr_b16 v[202:203], v238 offset:35168
    v_mfma_f32_16x16x32_bf16 v[52:55], v[204:207], v[180:183], v[52:55]
    ds_read_b128 v[164:167], v236 offset:2048
    v_mfma_f32_16x16x32_bf16 v[56:59], v[204:207], v[184:187], v[56:59]
    s_add_u32 m0, s57, 9216
    s_mul_i32 s47, s3, s48
    buffer_load_dwordx4 v241, s[28:31], s46 offen lds
    s_add_u32 s47, s47, s62
    v_mfma_f32_16x16x32_bf16 v[60:63], v[204:207], v[188:191], v[60:63]
    s_cmp_lg_u32 s43, 3
    s_cbranch_scc1 K1_P1_1_3
    v_mfma_f32_16x16x32_bf16 v[212:215], v[204:207], v[224:227], v[212:215]
K1_P1_1_3:
    s_waitcnt lgkmcnt(8)
    v_mfma_f32_16x16x32_bf16 v[64:67], v[208:211], v[176:179], v[64:67]
    ds_read_b64_tr_b16 v[204:205], v239 offset:41984
    ds_read_b64_tr_b16 v[206:207], v239 offset:42496
    v_mfma_f32_16x16x32_bf16 v[68:71], v[208:211], v[180:183], v[68:71]
    ds_read_b128 v[168:171], v236 offset:4096
    v_mfma_f32_16x16x32_bf16 v[72:75], v[208:211], v[184:187], v[72:75]
    s_add_u32 s57, s52, s49
    s_add_u32 m0, s57, 0
    s_add_u32 s3, s3, 1
    buffer_load_dwordx4 v242, s[32:35], s47 offen lds
    s_cmp_eq_u32 s3, 18
    s_cselect_b32 s3, 0, s3
    s_cmp_eq_u32 s3, s18
    s_cselect_b32 s3, 64, s3
    v_mfma_f32_16x16x32_bf16 v[76:79], v[208:211], v[188:191], v[76:79]
    s_cmp_lg_u32 s43, 0
    s_cbranch_scc1 K1_P1_1_4
    v_mfma_f32_16x16x32_bf16 v[216:219], v[208:211], v[224:227], v[216:219]
K1_P1_1_4:
    s_waitcnt lgkmcnt(9)
    v_mfma_f32_16x16x32_bf16 v[80:83], v[192:195], v[176:179], v[80:83]
    ds_read_b64_tr_b16 v[208:209], v240 offset:41984
    ds_read_b64_tr_b16 v[210:211], v240 offset:42496
    v_mfma_f32_16x16x32_bf16 v[84:87], v[192:195], v[180:183], v[84:87]
    ds_read_b128 v[172:175], v236 offset:6144
    v_mfma_f32_16x16x32_bf16 v[88:91], v[192:195], v[184:187], v[88:91]
    s_lshl_b32 s58, s19, 7
    s_add_u32 s58, s58, s45
    s_add_u32 s19, s19, 1
    s_cmp_eq_u32 s19, 9
    s_cselect_b32 s19, 0, s19
    s_cmp_eq_u32 s19, s60
    s_cselect_b32 s19, 0x800000, s19
    v_mfma_f32_16x16x32_bf16 v[92:95], v[192:195], v[188:191], v[92:95]
    s_cmp_lg_u32 s43, 1
    s_cbranch_scc1 K1_P1_1_5
    v_mfma_f32_16x16x32_bf16 v[216:219], v[192:195], v[224:227], v[216:219]
K1_P1_1_5:
    s_waitcnt lgkmcnt(10)
    v_add_u32 v238, s51, v238
    v_mfma_f32_16x16x32_bf16 v[96:99], v[196:199], v[176:179], v[96:99]
    ds_read_b64_tr_b16 v[192:193], v238 offset:0
    ds_read_b64_tr_b16 v[194:195], v238 offset:2304
    v_mfma_f32_16x16x32_bf16 v[100:103], v[196:199], v[180:183], v[100:103]
    v_mfma_f32_16x16x32_bf16 v[104:107], v[196:199], v[184:187], v[104:107]
    s_add_u32 m0, s52, s55
    s_nop 0
    buffer_load_dwordx4 v243, s[20:23], s58 offen lds
    v_mfma_f32_16x16x32_bf16 v[108:111], v[196:199], v[188:191], v[108:111]
    v_add_u32 v236, s59, v236
    s_cmp_lg_u32 s43, 2
    s_cbranch_scc1 K1_P1_1_6
    v_mfma_f32_16x16x32_bf16 v[216:219], v[196:199], v[224:227], v[216:219]
K1_P1_1_6:
    s_waitcnt lgkmcnt(9)
    v_add_u32 v239, s51, v239
    v_add_u32 v240, s51, v240
    v_mfma_f32_16x16x32_bf16 v[112:115], v[200:203], v[176:179], v[112:115]
    ds_read_b64_tr_b16 v[196:197], v238 offset:9216
    ds_read_b64_tr_b16 v[198:199], v238 offset:11520
    v_mfma_f32_16x16x32_bf16 v[116:119], v[200:203], v[180:183], v[116:119]
    v_mfma_f32_16x16x32_bf16 v[120:123], v[200:203], v[184:187], v[120:123]
    s_add_u32 m0, m0, 1024
    s_add_u32 s58, s58, 9216
    buffer_load_dwordx4 v244, s[20:23], s58 offen lds
    v_mfma_f32_16x16x32_bf16 v[124:127], v[200:203], v[188:191], v[124:127]
    s_cmp_lg_u32 s43, 3
    s_cbranch_scc1 K1_P1_1_7
    v_mfma_f32_16x16x32_bf16 v[216:219], v[200:203], v[224:227], v[216:219]
K1_P1_1_7:
    s_waitcnt lgkmcnt(8)
    v_mfma_f32_16x16x32_bf16 v[128:131], v[204:207], v[176:179], v[128:131]
    ds_read_b64_tr_b16 v[200:201], v238 offset:32
    ds_read_b64_tr_b16 v[202:203], v238 offset:2336
    v_mfma_f32_16x16x32_bf16 v[132:135], v[204:207], v[180:183], v[132:135]
    v_mfma_f32_16x16x32_bf16 v[136:139], v[204:207], v[184:187], v[136:139]
    s_add_u32 m0, m0, 1024
    s_add_u32 s58, s58, 9216
    buffer_load_dwordx4 v243, s[20:23], s58 offen lds
    v_mfma_f32_16x16x32_bf16 v[140:143], v[204:207], v[188:191], v[140:143]
    s_cmp_lg_u32 s43, 0
    s_cbranch_scc1 K1_P1_1_8
    v_mfma_f32_16x16x32_bf16 v[220:223], v[204:207], v[224:227], v[220:223]
K1_P1_1_8:
    s_waitcnt lgkmcnt(7)
    v_mfma_f32_16x16x32_bf16 v[144:147], v[208:211], v[176:179], v[144:147]
    ds_read_b64_tr_b16 v[204:205], v238 offset:9248
    ds_read_b64_tr_b16 v[206:207], v238 offset:11552
    v_mfma_f32_16x16x32_bf16 v[148:151], v[208:211], v[180:183], v[148:151]
    v_mfma_f32_16x16x32_bf16 v[152:155], v[208:211], v[184:187], v[152:155]
    s_add_u32 m0, m0, 1024
    s_add_u32 s58, s58, 9216
    buffer_load_dwordx4 v244, s[20:23], s58 offen lds
    v_mfma_f32_16x16x32_bf16 v[156:159], v[208:211], v[188:191], v[156:159]
    s_cmp_lg_u32 s43, 1
    s_cbranch_scc1 K1_P1_1_9
    v_mfma_f32_16x16x32_bf16 v[220:223], v[208:211], v[224:227], v[220:223]
K1_P1_1_9:
    s_mov_b32 s57, s52
    s_mov_b32 s52, s53
    s_mov_b32 s53, s57
    s_mov_b32 s57, s51
    s_mov_b32 s51, s59
    s_mov_b32 s59, s57
    s_add_u32 s50, s50, 1
    s_branch K1_HOOK1
.p2align 6
K1_LOOP1:
    s_waitcnt lgkmcnt(6)
    v_mfma_f32_16x16x32_bf16 v[0:3], v[192:195], v[160:163], v[0:3]
    ds_read_b64_tr_b16 v[208:209], v238 offset:64
    ds_read_b64_tr_b16 v[210:211], v238 offset:2368
    v_mfma_f32_16x16x32_bf16 v[4:7], v[192:195], v[164:167], v[4:7]
    v_mfma_f32_16x16x32_bf16 v[8:11], v[192:195], v[168:171], v[8:11]
    v_mfma_f32_16x16x32_bf16 v[12:15], v[192:195], v[172:175], v[12:15]
    s_waitcnt lgkmcnt(6)
    v_mfma_f32_16x16x32_bf16 v[16:19], v[196:199], v[160:163], v[16:19]
    ds_read_b64_tr_b16 v[192:193], v238 offset:9280
    ds_read_b64_tr_b16 v[194:195], v238 offset:11584
    v_mfma_f32_16x16x32_bf16 v[20:23], v[196:199], v[164:167], v[20:23]
    v_mfma_f32_16x16x32_bf16 v[24:27], v[196:199], v[168:171], v[24:27]
    v_mfma_f32_16x16x32_bf16 v[28:31], v[196:199], v[172:175], v[28:31]
    s_waitcnt vmcnt(7)
    s_barrier
    s_waitcnt lgkmcnt(6)
    v_mfma_f32_16x16x32_bf16 v[32:35], v[200:203], v[160:163], v[32:35]
    ds_read_b64_tr_b16 v[196:197], v238 offset:96
    ds_read_b64_tr_b16 v[198:199], v238 offset:2400
    v_mfma_f32_16x16x32_bf16 v[36:39], v[200:203], v[164:167], v[36:39]
    ds_read_b128 v[176:179], v237 offset:0
    v_mfma_f32_16x16x32_bf16 v[40:43], v[200:203], v[168:171], v[40:43]
    s_mul_i32 s46, s3, 294912
    s_add_u32 s57, s53, s54
    s_add_u32 m0, s57, 23552
    s_add_u32 s46, s46, s61
    buffer_load_dwordx4 v241, s[24:27], s46 offen lds
    v_mfma_f32_16x16x32_bf16 v[44:47], v[200:203], v[172:175], v[44:47]
    s_waitcnt lgkmcnt(7)
    v_mfma_f32_16x16x32_bf16 v[48:51], v[204:207], v[160:163], v[48:51]
    ds_read_b64_tr_b16 v[200:201], v238 offset:9312
    ds_read_b64_tr_b16 v[202:203], v238 offset:11616
    v_mfma_f32_16x16x32_bf16 v[52:55], v[204:207], v[164:167], v[52:55]
    ds_read_b128 v[180:183], v237 offset:2048
    v_mfma_f32_16x16x32_bf16 v[56:59], v[204:207], v[168:171], v[56:59]
    s_add_u32 m0, s57, 32768
    s_mul_i32 s47, s3, s48
    buffer_load_dwordx4 v241, s[28:31], s46 offen lds
    s_add_u32 s47, s47, s62
    v_mfma_f32_16x16x32_bf16 v[60:63], v[204:207], v[172:175], v[60:63]
    s_waitcnt lgkmcnt(8)
    v_mfma_f32_16x16x32_bf16 v[64:67], v[208:211], v[160:163], v[64:67]
    ds_read_b64_tr_b16 v[204:205], v239 offset:18432
    ds_read_b64_tr_b16 v[206:207], v239 offset:18944
    v_mfma_f32_16x16x32_bf16 v[68:71], v[208:211], v[164:167], v[68:71]
    ds_read_b128 v[184:187], v237 offset:4096
    v_mfma_f32_16x16x32_bf16 v[72:75], v[208:211], v[168:171], v[72:75]
    s_add_u32 s57, s53, s49
    s_add_u32 m0, s57, 23552
    s_add_u32 s3, s3, 1
    buffer_load_dwordx4 v242, s[32:35], s47 offen lds
    s_cmp_eq_u32 s3, 18
    s_cselect_b32 s3, 0, s3
    s_cmp_eq_u32 s3, s18
    s_cselect_b32 s3, 64, s3
    v_mfma_f32_16x16x32_bf16 v[76:79], v[208:211], v[172:175], v[76:79]
    s_waitcnt lgkmcnt(9)
    v_mfma_f32_16x16x32_bf16 v[80:83], v[192:195], v[160:163], v[80:83]
    ds_read_b64_tr_b16 v[208:209], v240 offset:18432
    ds_read_b64_tr_b16 v[210:211], v240 offset:18944
    v_mfma_f32_16x16x32_bf16 v[84:87], v[192:195], v[164:167], v[84:87]
    ds_read_b128 v[188:191], v237 offset:6144
    v_mfma_f32_16x16x32_bf16 v[88:91], v[192:195], v[168:171], v[88:91]
    s_cmp_lg_u32 s16, 0
    s_cbranch_scc1 K1_HOOKS
K1_HRET1:
    v_mfma_f32_16x16x32_bf16 v[92:95], v[192:195], v[172:175], v[92:95]
    s_waitcnt lgkmcnt(10)
    v_mfma_f32_16x16x32_bf16 v[96:99], v[196:199], v[160:163], v[96:99]
    ds_read_b64_tr_b16 v[192:193], v238 offset:23552
    ds_read_b64_tr_b16 v[194:195], v238 offset:25856
    v_mfma_f32_16x16x32_bf16 v[100:103], v[196:199], v[164:167], v[100:103]
    v_mfma_f32_16x16x32_bf16 v[104:107], v[196:199], v[168:171], v[104:107]
    v_mfma_f32_16x16x32_bf16 v[108:111], v[196:199], v[172:175], v[108:111]
    v_add_u32 v237, s51, v237
    s_waitcnt lgkmcnt(9)
    v_mfma_f32_16x16x32_bf16 v[112:115], v[200:203], v[160:163], v[112:115]
    ds_read_b64_tr_b16 v[196:197], v238 offset:32768
    ds_read_b64_tr_b16 v[198:199], v238 offset:35072
    v_mfma_f32_16x16x32_bf16 v[116:119], v[200:203], v[164:167], v[116:119]
    v_mfma_f32_16x16x32_bf16 v[120:123], v[200:203], v[168:171], v[120:123]
    v_mfma_f32_16x16x32_bf16 v[124:127], v[200:203], v[172:175], v[124:127]
    s_waitcnt lgkmcnt(8)
    v_mfma_f32_16x16x32_bf16 v[128:131], v[204:207], v[160:163], v[128:131]
    ds_read_b64_tr_b16 v[200:201], v238 offset:23584
    ds_read_b64_tr_b16 v[202:203], v238 offset:25888
    v_mfma_f32_16x16x32_bf16 v[132:135], v[204:207], v[164:167], v[132:135]
    v_mfma_f32_16x16x32_bf16 v[136:139], v[204:207], v[168:171], v[136:139]
    v_mfma_f32_16x16x32_bf16 v[140:143], v[204:207], v[172:175], v[140:143]
    s_waitcnt lgkmcnt(7)
    v_mfma_f32_16x16x32_bf16 v[144:147], v[208:211], v[160:163], v[144:147]
    ds_read_b64_tr_b16 v[204:205], v238 offset:32800
    ds_read_b64_tr_b16 v[206:207], v238 offset:35104
    v_mfma_f32_16x16x32_bf16 v[148:151], v[208:211], v[164:167], v[148:151]
    v_mfma_f32_16x16x32_bf16 v[152:155], v[208:211], v[168:171], v[152:155]
    v_mfma_f32_16x16x32_bf16 v[156:159], v[208:211], v[172:175], v[156:159]
    s_waitcnt lgkmcnt(6)
    v_mfma_f32_16x16x32_bf16 v[0:3], v[192:195], v[176:179], v[0:3]
    ds_read_b64_tr_b16 v[208:209], v238 offset:23616
    ds_read_b64_tr_b16 v[210:211], v238 offset:25920
    v_mfma_f32_16x16x32_bf16 v[4:7], v[192:195], v[180:183], v[4:7]
    v_mfma_f32_16x16x32_bf16 v[8:11], v[192:195], v[184:187], v[8:11]
    v_mfma_f32_16x16x32_bf16 v[12:15], v[192:195], v[188:191], v[12:15]
    s_waitcnt lgkmcnt(6)
    v_mfma_f32_16x16x32_bf16 v[16:19], v[196:199], v[176:179], v[16:19]
    ds_read_b64_tr_b16 v[192:193], v238 offset:32832
    ds_read_b64_tr_b16 v[194:195], v238 offset:35136
    v_mfma_f32_16x16x32_bf16 v[20:23], v[196:199], v[180:183], v[20:23]
    v_mfma_f32_16x16x32_bf16 v[24:27], v[196:199], v[184:187], v[24:27]
    v_mfma_f32_16x16x32_bf16 v[28:31], v[196:199], v[188:191], v[28:31]
    s_cmp_lg_u32 s16, 0
    s_cbranch_scc1 K1_NOW1
    s_waitcnt vmcnt(3)
    s_branch K1_W21
K1_NOW1:
    s_waitcnt vmcnt(6)
K1_W21:
    s_barrier
    s_waitcnt lgkmcnt(6)
    v_mfma_f32_16x16x32_bf16 v[32:35], v[200:203], v[176:179], v[32:35]
    ds_read_b64_tr_b16 v[196:197], v238 offset:23648
    ds_read_b64_tr_b16 v[198:199], v238 offset:25952
    v_mfma_f32_16x16x32_bf16 v[36:39], v[200:203], v[180:183], v[36:39]
    ds_read_b128 v[160:163], v236 offset:0
    v_mfma_f32_16x16x32_bf16 v[40:43], v[200:203], v[184:187], v[40:43]
    s_mul_i32 s46, s3, 294912
    s_add_u32 s57, s52, s54
    s_add_u32 m0, s57, 0
    s_add_u32 s46, s46, s61
    buffer_load_dwordx4 v241, s[24:27], s46 offen lds
    v_mfma_f32_16x16x32_bf16 v[44:47], v[200:203], v[188:191], v[44:47]
    s_waitcnt lgkmcnt(7)
    v_mfma_f32_16x16x32_bf16 v[48:51], v[204:207], v[176:179], v[48:51]
    ds_read_b64_tr_b16 v[200:201], v238 offset:32864
    ds_read_b64_tr_b16 v[202:203], v238 offset:35168
    v_mfma_f32_16x16x32_bf16 v[52:55], v[204:207], v[180:183], v[52:55]
    ds_read_b128 v[164:167], v236 offset:2048
    v_mfma_f32_16x16x32_bf16 v[56:59], v[204:207], v[184:187], v[56:59]
    s_add_u32 m0, s57, 9216
    s_mul_i32 s47, s3, s48
    buffer_load_dwordx4 v241, s[28:31], s46 offen lds
    s_add_u32 s47, s47, s62
    v_mfma_f32_16x16x32_bf16 v[60:63], v[204:207], v[188:191], v[60:63]
    s_waitcnt lgkmcnt(8)
    v_mfma_f32_16x16x32_bf16 v[64:67], v[208:211], v[176:179], v[64:67]
    ds_read_b64_tr_b16 v[204:205], v239 offset:41984
    ds_read_b64_tr_b16 v[206:207], v239 offset:42496
    v_mfma_f32_16x16x32_bf16 v[68:71], v[208:211], v[180:183], v[68:71]
    ds_read_b128 v[168:171], v236 offset:4096
    v_mfma_f32_16x16x32_bf16 v[72:75], v[208:211], v[184:187], v[72:75]
    s_add_u32 s57, s52, s49
    s_add_u32 m0, s57, 0
    s_add_u32 s3, s3, 1
    buffer_load_dwordx4 v242, s[32:35], s47 offen lds
    s_cmp_eq_u32 s3, 18
    s_cselect_b32 s3, 0, s3
    s_cmp_eq_u32 s3, s18
    s_cselect_b32 s3, 64, s3
    v_mfma_f32_16x16x32_bf16 v[76:79], v[208:211], v[188:191], v[76:79]
    s_waitcnt lgkmcnt(9)
    v_mfma_f32_16x16x32_bf16 v[80:83], v[192:195], v[176:179], v[80:83]
    ds_read_b64_tr_b16 v[208:209], v240 offset:41984
    ds_read_b64_tr_b16 v[210:211], v240 offset:42496
    v_mfma_f32_16x16x32_bf16 v[84:87], v[192:195], v[180:183], v[84:87]
    ds_read_b128 v[172:175], v236 offset:6144
    v_mfma_f32_16x16x32_bf16 v[88:91], v[192:195], v[184:187], v[88:91]
    s_lshl_b32 s58, s19, 7
    s_add_u32 s58, s58, s45
    s_add_u32 s19, s19, 1
    s_cmp_eq_u32 s19, 9
    s_cselect_b32 s19, 0, s19
    s_cmp_eq_u32 s19, s60
    s_cselect_b32 s19, 0x800000, s19
    v_mfma_f32_16x16x32_bf16 v[92:95], v[192:195], v[188:191], v[92:95]
    s_waitcnt lgkmcnt(10)
    v_add_u32 v238, s51, v238
    v_mfma_f32_16x16x32_bf16 v[96:99], v[196:199], v[176:179], v[96:99]
    ds_read_b64_tr_b16 v[192:193], v238 offset:0
    ds_read_b64_tr_b16 v[194:195], v238 offset:2304
    v_mfma_f32_16x16x32_bf16 v[100:103], v[196:199], v[180:183], v[100:103]
    v_mfma_f32_16x16x32_bf16 v[104:107], v[196:199], v[184:187], v[104:107]
    s_add_u32 m0, s52, s55
    s_nop 0
    buffer_load_dwordx4 v243, s[20:23], s58 offen lds
    v_mfma_f32_16x16x32_bf16 v[108:111], v[196:199], v[188:191], v[108:111]
    v_add_u32 v236, s59, v236
    s_waitcnt lgkmcnt(9)
    v_add_u32 v239, s51, v239
    v_add_u32 v240, s51, v240
    v_mfma_f32_16x16x32_bf16 v[112:115], v[200:203], v[176:179], v[112:115]
    ds_read_b64_tr_b16 v[196:197], v238 offset:9216
    ds_read_b64_tr_b16 v[198:199], v238 offset:11520
    v_mfma_f32_16x16x32_bf16 v[116:119], v[200:203], v[180:183], v[116:119]
    v_mfma_f32_16x16x32_bf16 v[120:123], v[200:203], v[184:187], v[120:123]
    s_add_u32 m0, m0, 1024
    s_add_u32 s58, s58, 9216
    buffer_load_dwordx4 v244, s[20:23], s58 offen lds
    v_mfma_f32_16x16x32_bf16 v[124:127], v[200:203], v[188:191], v[124:127]
    s_waitcnt lgkmcnt(8)
    v_mfma_f32_16x16x32_bf16 v[128:131], v[204:207], v[176:179], v[128:131]
    ds_read_b64_tr_b16 v[200:201], v238 offset:32
    ds_read_b64_tr_b16 v[202:203], v238 offset:2336
    v_mfma_f32_16x16x32_bf16 v[132:135], v[204:207], v[180:183], v[132:135]
    v_mfma_f32_16x16x32_bf16 v[136:139], v[204:207], v[184:187], v[136:139]
    s_add_u32 m0, m0, 1024
    s_add_u32 s58, s58, 9216
    buffer_load_dwordx4 v243, s[20:23], s58 offen lds
    v_mfma_f32_16x16x32_bf16 v[140:143], v[204:207], v[188:191], v[140:143]
    s_waitcnt lgkmcnt(7)
    v_mfma_f32_16x16x32_bf16 v[144:147], v[208:211], v[176:179], v[144:147]
    ds_read_b64_tr_b16 v[204:205], v238 offset:9248
    ds_read_b64_tr_b16 v[206:207], v238 offset:11552
    v_mfma_f32_16x16x32_bf16 v[148:151], v[208:211], v[180:183], v[148:151]
    v_mfma_f32_16x16x32_bf16 v[152:155], v[208:211], v[184:187], v[152:155]
    s_add_u32 m0, m0, 1024
    s_add_u32 s58, s58, 9216
    buffer_load_dwordx4 v244, s[20:23], s58 offen lds
    v_mfma_f32_16x16x32_bf16 v[156:159], v[208:211], v[188:191], v[156:159]
    s_mov_b32 s57, s52
    s_mov_b32 s52, s53
    s_mov_b32 s53, s57
    s_mov_b32 s57, s51
    s_mov_b32 s51, s59
    s_mov_b32 s59, s57
    s_add_u32 s50, s50, 1
K1_HOOK1:
    s_lshl_b32 s16, 1, s50
    s_and_b32 s57, s16, s101
    s_cbranch_scc1 K1_PROD1
    s_and_b32 s16, s16, s17
    s_cmp_lt_u32 s50, 8
    s_cbranch_scc1 K1_LOOP1
    v_and_b32 v251, 15, v255
    v_lshlrev_b32 v251, 4, v251
    v_lshlrev_b32 v252, 2, v255
    s_lshl_b32 s63, s41, 12
    s_lshl_b32 s58, s43, 10
    s_add_u32 s63, s63, s58
    s_add_u32 s63, s63, 44040192
    s_mul_i32 s47, s40, 10240
    s_lshl_b32 s58, s42, 8
    s_add_u32 s47, s47, s58
    s_add_u32 s47, s47, 44105728
    s_cmp_ge_u32 s42, 5
    s_cselect_b32 s47, 0x70000000, s47
    s_waitcnt vmcnt(7)
    s_barrier
    v_cmp_ne_u32 vcc, 0x01010101, v245
    s_nop 4
    s_cmp_eq_u64 vcc, 0
    s_cbranch_scc1 K1_LGO1
    v_mov_b32 v246, 81152
    v_mov_b32 v247, 1
    s_mov_b32 s63, 0x70000000
    s_mov_b32 s47, 0x70000000
    s_waitcnt lgkmcnt(0)
    ds_write_b32 v246, v247
    s_waitcnt lgkmcnt(0)
K1_LGO1:
    s_waitcnt lgkmcnt(6)
    v_mfma_f32_16x16x32_bf16 v[0:3], v[192:195], v[160:163], v[0:3]
    ds_read_b64_tr_b16 v[208:209], v238 offset:64
    ds_read_b64_tr_b16 v[210:211], v238 offset:2368
    v_mfma_f32_16x16x32_bf16 v[4:7], v[192:195], v[164:167], v[4:7]
    v_mfma_f32_16x16x32_bf16 v[8:11], v[192:195], v[168:171], v[8:11]
    v_mfma_f32_16x16x32_bf16 v[12:15], v[192:195], v[172:175], v[12:15]
    s_waitcnt lgkmcnt(6)
    v_mfma_f32_16x16x32_bf16 v[16:19], v[196:199], v[160:163], v[16:19]
    ds_read_b64_tr_b16 v[192:193], v238 offset:9280
    ds_read_b64_tr_b16 v[194:195], v238 offset:11584
    v_mfma_f32_16x16x32_bf16 v[20:23], v[196:199], v[164:167], v[20:23]
    v_mfma_f32_16x16x32_bf16 v[24:27], v[196:199], v[168:171], v[24:27]
    v_mfma_f32_16x16x32_bf16 v[28:31], v[196:199], v[172:175], v[28:31]
    s_waitcnt lgkmcnt(6)
    v_mfma_f32_16x16x32_bf16 v[32:35], v[200:203], v[160:163], v[32:35]
    ds_read_b64_tr_b16 v[196:197], v238 offset:96
    ds_read_b64_tr_b16 v[198:199], v238 offset:2400
    v_mfma_f32_16x16x32_bf16 v[36:39], v[200:203], v[164:167], v[36:39]
    ds_read_b128 v[176:179], v237 offset:0
    v_mfma_f32_16x16x32_bf16 v[40:43], v[200:203], v[168:171], v[40:43]
    buffer_load_dwordx4 v[212:215], v251, s[36:39], s63 offen offset:0 sc1
    buffer_load_dwordx4 v[216:219], v251, s[36:39], s63 offen offset:256 sc1
    v_mfma_f32_16x16x32_bf16 v[44:47], v[200:203], v[172:175], v[44:47]
    s_waitcnt lgkmcnt(7)
    v_mfma_f32_16x16x32_bf16 v[48:51], v[204:207], v[160:163], v[48:51]
    ds_read_b64_tr_b16 v[200:201], v238 offset:9312
    ds_read_b64_tr_b16 v[202:203], v238 offset:11616
    v_mfma_f32_16x16x32_bf16 v[52:55], v[204:207], v[164:167], v[52:55]
    ds_read_b128 v[180:183], v237 offset:2048
    v_mfma_f32_16x16x32_bf16 v[56:59], v[204:207], v[168:171], v[56:59]
    buffer_load_dwordx4 v[220:223], v251, s[36:39], s63 offen offset:512 sc1
    buffer_load_dwordx4 v[224:227], v251, s[36:39], s63 offen offset:768 sc1
    v_mfma_f32_16x16x32_bf16 v[60:63], v[204:207], v[172:175], v[60:63]
    s_waitcnt lgkmcnt(8)
    v_mfma_f32_16x16x32_bf16 v[64:67], v[208:211], v[160:163], v[64:67]
    ds_read_b64_tr_b16 v[204:205], v239 offset:18432
    ds_read_b64_tr_b16 v[206:207], v239 offset:18944
    v_mfma_f32_16x16x32_bf16 v[68:71], v[208:211], v[164:167], v[68:71]
    ds_read_b128 v[184:187], v237 offset:4096
    v_mfma_f32_16x16x32_bf16 v[72:75], v[208:211], v[168:171], v[72:75]
    buffer_load_dword v228, v252, s[36:39], s47 offen offset:0 sc1
    buffer_load_dword v229, v252, s[36:39], s47 offen offset:1280 sc1
    v_mfma_f32_16x16x32_bf16 v[76:79], v[208:211], v[172:175], v[76:79]
    s_waitcnt lgkmcnt(9)
    v_mfma_f32_16x16x32_bf16 v[80:83], v[192:195], v[160:163], v[80:83]
    ds_read_b64_tr_b16 v[208:209], v240 offset:18432
    ds_read_b64_tr_b16 v[210:211], v240 offset:18944
    v_mfma_f32_16x16x32_bf16 v[84:87], v[192:195], v[164:167], v[84:87]
    ds_read_b128 v[188:191], v237 offset:6144
    v_mfma_f32_16x16x32_bf16 v[88:91], v[192:195], v[168:171], v[88:91]
    buffer_load_dword v230, v252, s[36:39], s47 offen offset:2560 sc1
    s_add_u32 s47, s47, 3840
    buffer_load_dword v231, v252, s[36:39], s47 offen offset:0 sc1
    v_mfma_f32_16x16x32_bf16 v[92:95], v[192:195], v[172:175], v[92:95]
    s_waitcnt lgkmcnt(10)
    v_mfma_f32_16x16x32_bf16 v[96:99], v[196:199], v[160:163], v[96:99]
    ds_read_b64_tr_b16 v[192:193], v238 offset:23552
    ds_read_b64_tr_b16 v[194:195], v238 offset:25856
    v_mfma_f32_16x16x32_bf16 v[100:103], v[196:199], v[164:167], v[100:103]
    v_mfma_f32_16x16x32_bf16 v[104:107], v[196:199], v[168:171], v[104:107]
    buffer_load_dword v232, v252, s[36:39], s47 offen offset:1280 sc1
    buffer_load_dword v233, v252, s[36:39], s47 offen offset:2560 sc1
    v_mfma_f32_16x16x32_bf16 v[108:111], v[196:199], v[172:175], v[108:111]
    v_add_u32 v237, s51, v237
    s_waitcnt lgkmcnt(9)
    v_mfma_f32_16x16x32_bf16 v[112:115], v[200:203], v[160:163], v[112:115]
    ds_read_b64_tr_b16 v[196:197], v238 offset:32768
    ds_read_b64_tr_b16 v[198:199], v238 offset:35072
    v_mfma_f32_16x16x32_bf16 v[116:119], v[200:203], v[164:167], v[116:119]
    v_mfma_f32_16x16x32_bf16 v[120:123], v[200:203], v[168:171], v[120:123]
    s_add_u32 s47, s47, 3840
    buffer_load_dword v234, v252, s[36:39], s47 offen offset:0 sc1
    buffer_load_dword v235, v252, s[36:39], s47 offen offset:1280 sc1
    v_mfma_f32_16x16x32_bf16 v[124:127], v[200:203], v[172:175], v[124:127]
    s_waitcnt lgkmcnt(8)
    v_mfma_f32_16x16x32_bf16 v[128:131], v[204:207], v[160:163], v[128:131]
    ds_read_b64_tr_b16 v[200:201], v238 offset:23584
    ds_read_b64_tr_b16 v[202:203], v238 offset:25888
    v_mfma_f32_16x16x32_bf16 v[132:135], v[204:207], v[164:167], v[132:135]
    v_mfma_f32_16x16x32_bf16 v[136:139], v[204:207], v[168:171], v[136:139]
    v_mfma_f32_16x16x32_bf16 v[140:143], v[204:207], v[172:175], v[140:143]
    s_waitcnt lgkmcnt(7)
    v_mfma_f32_16x16x32_bf16 v[144:147], v[208:211], v[160:163], v[144:147]
    ds_read_b64_tr_b16 v[204:205], v238 offset:32800
    ds_read_b64_tr_b16 v[206:207], v238 offset:35104
    v_mfma_f32_16x16x32_bf16 v[148:151], v[208:211], v[164:167], v[148:151]
    v_mfma_f32_16x16x32_bf16 v[152:155], v[208:211], v[168:171], v[152:155]
    v_mfma_f32_16x16x32_bf16 v[156:159], v[208:211], v[172:175], v[156:159]
    s_waitcnt lgkmcnt(6)
    v_mfma_f32_16x16x32_bf16 v[0:3], v[192:195], v[176:179], v[0:3]
    ds_read_b64_tr_b16 v[208:209], v238 offset:23616
    ds_read_b64_tr_b16 v[210:211], v238 offset:25920
    v_mfma_f32_16x16x32_bf16 v[4:7], v[192:195], v[180:183], v[4:7]
    v_mfma_f32_16x16x32_bf16 v[8:11], v[192:195], v[184:187], v[8:11]
    v_mfma_f32_16x16x32_bf16 v[12:15], v[192:195], v[188:191], v[12:15]
    s_waitcnt lgkmcnt(6)
    v_mfma_f32_16x16x32_bf16 v[16:19], v[196:199], v[176:179], v[16:19]
    ds_read_b64_tr_b16 v[192:193], v238 offset:32832
    ds_read_b64_tr_b16 v[194:195], v238 offset:35136
    v_mfma_f32_16x16x32_bf16 v[20:23], v[196:199], v[180:183], v[20:23]
    v_mfma_f32_16x16x32_bf16 v[24:27], v[196:199], v[184:187], v[24:27]
    v_mfma_f32_16x16x32_bf16 v[28:31], v[196:199], v[188:191], v[28:31]
    s_waitcnt lgkmcnt(6)
    v_mfma_f32_16x16x32_bf16 v[32:35], v[200:203], v[176:179], v[32:35]
    ds_read_b64_tr_b16 v[196:197], v238 offset:23648
    ds_read_b64_tr_b16 v[198:199], v238 offset:25952
    v_mfma_f32_16x16x32_bf16 v[36:39], v[200:203], v[180:183], v[36:39]
    v_mfma_f32_16x16x32_bf16 v[40:43], v[200:203], v[184:187], v[40:43]
    v_mfma_f32_16x16x32_bf16 v[44:47], v[200:203], v[188:191], v[44:47]
    s_waitcnt lgkmcnt(6)
    v_mfma_f32_16x16x32_bf16 v[48:51], v[204:207], v[176:179], v[48:51]
    ds_read_b64_tr_b16 v[200:201], v238 offset:32864
    ds_read_b64_tr_b16 v[202:203], v238 offset:35168
    v_mfma_f32_16x16x32_bf16 v[52:55], v[204:207], v[180:183], v[52:55]
    v_mfma_f32_16x16x32_bf16 v[56:59], v[204:207], v[184:187], v[56:59]
    v_mfma_f32_16x16x32_bf16 v[60:63], v[204:207], v[188:191], v[60:63]
    s_waitcnt lgkmcnt(6)
    v_mfma_f32_16x16x32_bf16 v[64:67], v[208:211], v[176:179], v[64:67]
    ds_read_b64_tr_b16 v[204:205], v239 offset:41984
    ds_read_b64_tr_b16 v[206:207], v239 offset:42496
    v_mfma_f32_16x16x32_bf16 v[68:71], v[208:211], v[180:183], v[68:71]
    v_mfma_f32_16x16x32_bf16 v[72:75], v[208:211], v[184:187], v[72:75]
    v_mfma_f32_16x16x32_bf16 v[76:79], v[208:211], v[188:191], v[76:79]
    s_waitcnt lgkmcnt(6)
    v_mfma_f32_16x16x32_bf16 v[80:83], v[192:195], v[176:179], v[80:83]
    ds_read_b64_tr_b16 v[208:209], v240 offset:41984
    ds_read_b64_tr_b16 v[210:211], v240 offset:42496
    v_mfma_f32_16x16x32_bf16 v[84:87], v[192:195], v[180:183], v[84:87]
    v_mfma_f32_16x16x32_bf16 v[88:91], v[192:195], v[184:187], v[88:91]
    v_mfma_f32_16x16x32_bf16 v[92:95], v[192:195], v[188:191], v[92:95]
    s_waitcnt lgkmcnt(6)
    v_add_u32 v238, s51, v238
    v_mfma_f32_16x16x32_bf16 v[96:99], v[196:199], v[176:179], v[96:99]
    v_mfma_f32_16x16x32_bf16 v[100:103], v[196:199], v[180:183], v[100:103]
    v_mfma_f32_16x16x32_bf16 v[104:107], v[196:199], v[184:187], v[104:107]
    v_mfma_f32_16x16x32_bf16 v[108:111], v[196:199], v[188:191], v[108:111]
    v_add_u32 v236, s59, v236
    s_waitcnt lgkmcnt(4)
    v_add_u32 v239, s51, v239
    v_add_u32 v240, s51, v240
    s_waitcnt vmcnt(0)
    s_cmp_ge_u32 s42, 5
    s_cbranch_scc1 K1_NORED
    v_add_f32 v228, v228, v232
    v_add_f32 v229, v229, v233
    v_add_f32 v230, v230, v234
    v_add_f32 v231, v231, v235
    v_add_f32 v228, v228, v229
    v_add_f32 v230, v230, v231
    s_lshl_b32 s57, s42, 8
    s_add_u32 s57, s57, 79872
    v_add_f32 v228, v228, v230
    v_lshl_add_u32 v246, v255, 2, s57
    ds_write_b32 v246, v228
K1_NORED:
    s_waitcnt lgkmcnt(0)
    s_barrier
    v_mfma_f32_16x16x32_bf16 v[112:115], v[200:203], v[176:179], v[112:115]
    v_mfma_f32_16x16x32_bf16 v[116:119], v[200:203], v[180:183], v[116:119]
    v_mfma_f32_16x16x32_bf16 v[120:123], v[200:203], v[184:187], v[120:123]
    v_mfma_f32_16x16x32_bf16 v[124:127], v[200:203], v[188:191], v[124:127]
    v_mfma_f32_16x16x32_bf16 v[128:131], v[204:207], v[176:179], v[128:131]
    v_mfma_f32_16x16x32_bf16 v[132:135], v[204:207], v[180:183], v[132:135]
    v_mfma_f32_16x16x32_bf16 v[136:139], v[204:207], v[184:187], v[136:139]
    v_mfma_f32_16x16x32_bf16 v[140:143], v[204:207], v[188:191], v[140:143]
    v_mfma_f32_16x16x32_bf16 v[144:147], v[208:211], v[176:179], v[144:147]
    v_mfma_f32_16x16x32_bf16 v[148:151], v[208:211], v[180:183], v[148:151]
    v_mfma_f32_16x16x32_bf16 v[152:155], v[208:211], v[184:187], v[152:155]
    v_mfma_f32_16x16x32_bf16 v[156:159], v[208:211], v[188:191], v[156:159]
    s_mov_b32 s57, s52
    s_mov_b32 s52, s53
    s_mov_b32 s53, s57
    s_mov_b32 s57, s51
    s_mov_b32 s51, s59
    s_mov_b32 s59, s57
    s_add_u32 s50, s50, 1
    s_branch K1_EPI
K1_HOOKS:
    s_cmp_eq_u32 s50, 7
    s_cbranch_scc1 K1_H7
    s_cmp_lg_u32 s50, 3
    s_cbranch_scc1 K1_H3
    v_and_b32 v246, 48, v255
    s_lshl_b32 s63, s40, 3
    s_add_u32 s63, s63, s41
    s_mul_i32 s63, s63, 20
    s_mul_i32 s58, s44, 10
    s_add_u32 s63, s63, s58
    s_add_u32 s63, s63, s43
    s_lshl_b32 s63, s63, 6
    s_add_u32 s63, s63, 44105728
    s_mov_b32 exec_lo, 0x00010001
    s_mov_b32 exec_hi, 0x00010001
    buffer_store_dwordx4 v[212:215], v246, s[36:39], s63 offen offset:0 sc1
    buffer_store_dwordx4 v[216:219], v246, s[36:39], s63 offen offset:256 sc1
    s_cmp_ge_u32 s43, 2
    s_cselect_b32 s63, 0x70000000, s63
    buffer_store_dwordx4 v[220:223], v246, s[36:39], s63 offen offset:512 sc1
    s_mov_b64 exec, -1
    s_branch K1_HRET
K1_H3:
    v_mov_b32 v246, 0
    v_mov_b32 v247, 1
    s_mov_b32 s63, 0x70000000
    s_mov_b64 exec, 1
    buffer_store_byte v247, v246, s[64:67], s2 offen sc1
    buffer_store_byte v247, v246, s[64:67], s63 offen
    buffer_store_byte v247, v246, s[64:67], s63 offen
    s_mov_b64 exec, -1
    s_branch K1_HRET
K1_H7:
    v_lshlrev_b32 v246, 2, v255
    s_mov_b32 s63, 0x70000000
    buffer_load_dword v245, v246, s[64:67], 0 offen sc1
    buffer_load_dword v247, v246, s[64:67], s63 offen
    buffer_load_dword v247, v246, s[64:67], s63 offen
K1_HRET:
    s_cmp_eq_u32 s44, 0
    s_cbranch_scc1 K1_HRET0
    s_branch K1_HRET1
K1_EPI:
    v_mov_b32 v246, 81152
    ds_read_b32 v247, v246
    s_waitcnt lgkmcnt(0)
    v_readfirstlane_b32 s57, v247
    s_cmp_lg_u32 s57, 0
    s_cbranch_scc1 K1_SLOW
K1_EPI2:
    v_lshrrev_b32 v247, 4, v255
    s_mul_i32 s57, s44, 640
    s_add_u32 s57, s57, 79872
    v_lshl_add_u32 v248, v247, 4, s57
    ds_read_b128 v[160:163], v248 offset:0
    ds_read_b128 v[164:167], v248 offset:64
    ds_read_b128 v[168:171], v248 offset:128
    ds_read_b128 v[172:175], v248 offset:192
    ds_read_b128 v[176:179], v248 offset:256
    ds_read_b128 v[180:183], v248 offset:320
    ds_read_b128 v[184:187], v248 offset:384
    ds_read_b128 v[188:191], v248 offset:448
    ds_read_b128 v[192:195], v248 offset:512
    ds_read_b128 v[196:199], v248 offset:576
    v_and_b32 v246, 15, v255
    v_lshrrev_b32 v249, 5, v255
    v_lshl_add_u32 v249, v249, 4, v246
    v_and_b32 v250, 1, v247
    v_lshl_add_u32 v249, v250, 5, v249
    v_lshlrev_b32 v249, 4, v249
    s_lshl_b32 s57, s41, 3
    s_lshl_b32 s58, s43, 1
    s_add_u32 s61, s57, s58
    s_mul_i32 s60, s61, 288
    s_mul_i32 s57, s40, 9
    s_add_u32 s60, s60, s57
    s_mul_i32 s57, s44, 5
    s_add_u32 s60, s60, s57
    s_lshl_b32 s60, s60, 10
    s_waitcnt lgkmcnt(0)
    v_pk_fma_f32 v[0:1], v[212:213], v[160:161], v[0:1] op_sel_hi:[0,1,1]
    v_pk_fma_f32 v[2:3], v[212:213], v[162:163], v[2:3] op_sel_hi:[0,1,1]
    v_pk_fma_f32 v[4:5], v[216:217], v[160:161], v[4:5] op_sel_hi:[0,1,1]
    v_pk_fma_f32 v[6:7], v[216:217], v[162:163], v[6:7] op_sel_hi:[0,1,1]
    v_pk_mul_f32 v[228:229], v[0:1], v[212:213] op_sel:[0,1] op_sel_hi:[1,1]
    v_pk_mul_f32 v[230:231], v[2:3], v[212:213] op_sel:[0,1] op_sel_hi:[1,1]
    v_pk_mul_f32 v[232:233], v[4:5], v[216:217] op_sel:[0,1] op_sel_hi:[1,1]
    v_pk_mul_f32 v[234:235], v[6:7], v[216:217] op_sel:[0,1] op_sel_hi:[1,1]
    v_exp_f32 v228, v228
    v_exp_f32 v229, v229
    v_exp_f32 v230, v230
    v_exp_f32 v231, v231
    v_exp_f32 v232, v232
    v_exp_f32 v233, v233
    v_exp_f32 v234, v234
    v_exp_f32 v235, v235
    v_pk_fma_f32 v[16:17], v[212:213], v[164:165], v[16:17] op_sel_hi:[0,1,1]
    v_pk_fma_f32 v[18:19], v[212:213], v[166:167], v[18:19] op_sel_hi:[0,1,1]
    v_pk_fma_f32 v[20:21], v[216:217], v[164:165], v[20:21] op_sel_hi:[0,1,1]
    v_pk_fma_f32 v[22:23], v[216:217], v[166:167], v[22:23] op_sel_hi:[0,1,1]
    v_pk_fma_f32 v[228:229], v[228:229], v[214:215], v[214:215] op_sel_hi:[1,0,0]
    v_pk_fma_f32 v[230:231], v[230:231], v[214:215], v[214:215] op_sel_hi:[1,0,0]
    v_pk_fma_f32 v[232:233], v[232:233], v[218:219], v[218:219] op_sel_hi:[1,0,0]
    v_pk_fma_f32 v[234:235], v[234:235], v[218:219], v[218:219] op_sel_hi:[1,0,0]
    v_rcp_f32 v228, v228
    v_rcp_f32 v229, v229
    v_rcp_f32 v230, v230
    v_rcp_f32 v231, v231
    v_rcp_f32 v232, v232
    v_rcp_f32 v233, v233
    v_rcp_f32 v234, v234
    v_rcp_f32 v235, v235
    v_pk_mul_f32 v[0:1], v[0:1], v[16:17]
    v_pk_mul_f32 v[2:3], v[2:3], v[18:19]
    v_pk_mul_f32 v[4:5], v[4:5], v[20:21]
    v_pk_mul_f32 v[6:7], v[6:7], v[22:23]
    v_pk_mul_f32 v[0:1], v[0:1], v[228:229]
    v_pk_mul_f32 v[2:3], v[2:3], v[230:231]
    v_pk_mul_f32 v[4:5], v[4:5], v[232:233]
    v_pk_mul_f32 v[6:7], v[6:7], v[234:235]
    v_cvt_pk_bf16_f32 v16, v0, v1
    v_cvt_pk_bf16_f32 v17, v2, v3
    v_cvt_pk_bf16_f32 v18, v4, v5
    v_cvt_pk_bf16_f32 v19, v6, v7
    s_add_u32 s57, s60, 0
    s_nop 0
    v_permlane32_swap_b32 v16, v18
    v_permlane32_swap_b32 v17, v19
    s_nop 0
    buffer_store_dwordx4 v[16:19], v249, s[36:39], s57 offen sc1
    v_pk_fma_f32 v[8:9], v[220:221], v[160:161], v[8:9] op_sel_hi:[0,1,1]
    v_pk_fma_f32 v[10:11], v[220:221], v[162:163], v[10:11] op_sel_hi:[0,1,1]
    v_pk_fma_f32 v[12:13], v[224:225], v[160:161], v[12:13] op_sel_hi:[0,1,1]
    v_pk_fma_f32 v[14:15], v[224:225], v[162:163], v[14:15] op_sel_hi:[0,1,1]
    v_pk_mul_f32 v[228:229], v[8:9], v[220:221] op_sel:[0,1] op_sel_hi:[1,1]
    v_pk_mul_f32 v[230:231], v[10:11], v[220:221] op_sel:[0,1] op_sel_hi:[1,1]
    v_pk_mul_f32 v[232:233], v[12:13], v[224:225] op_sel:[0,1] op_sel_hi:[1,1]
    v_pk_mul_f32 v[234:235], v[14:15], v[224:225] op_sel:[0,1] op_sel_hi:[1,1]
    v_exp_f32 v228, v228
    v_exp_f32 v229, v229
    v_exp_f32 v230, v230
    v_exp_f32 v231, v231
    v_exp_f32 v232, v232
    v_exp_f32 v233, v233
    v_exp_f32 v234, v234
    v_exp_f32 v235, v235
    v_pk_fma_f32 v[24:25], v[220:221], v[164:165], v[24:25] op_sel_hi:[0,1,1]
    v_pk_fma_f32 v[26:27], v[220:221], v[166:167], v[26:27] op_sel_hi:[0,1,1]
    v_pk_fma_f32 v[28:29], v[224:225], v[164:165], v[28:29] op_sel_hi:[0,1,1]
    v_pk_fma_f32 v[30:31], v[224:225], v[166:167], v[30:31] op_sel_hi:[0,1,1]
    v_pk_fma_f32 v[228:229], v[228:229], v[222:223], v[222:223] op_sel_hi:[1,0,0]
    v_pk_fma_f32 v[230:231], v[230:231], v[222:223], v[222:223] op_sel_hi:[1,0,0]
    v_pk_fma_f32 v[232:233], v[232:233], v[226:227], v[226:227] op_sel_hi:[1,0,0]
    v_pk_fma_f32 v[234:235], v[234:235], v[226:227], v[226:227] op_sel_hi:[1,0,0]
    v_rcp_f32 v228, v228
    v_rcp_f32 v229, v229
    v_rcp_f32 v230, v230
    v_rcp_f32 v231, v231
    v_rcp_f32 v232, v232
    v_rcp_f32 v233, v233
    v_rcp_f32 v234, v234
    v_rcp_f32 v235, v235
    v_pk_mul_f32 v[8:9], v[8:9], v[24:25]
    v_pk_mul_f32 v[10:11], v[10:11], v[26:27]
    v_pk_mul_f32 v[12:13], v[12:13], v[28:29]
    v_pk_mul_f32 v[14:15], v[14:15], v[30:31]
    v_pk_mul_f32 v[8:9], v[8:9], v[228:229]
    v_pk_mul_f32 v[10:11], v[10:11], v[230:231]
    v_pk_mul_f32 v[12:13], v[12:13], v[232:233]
    v_pk_mul_f32 v[14:15], v[14:15], v[234:235]
    v_cvt_pk_bf16_f32 v24, v8, v9
    v_cvt_pk_bf16_f32 v25, v10, v11
    v_cvt_pk_bf16_f32 v26, v12, v13
    v_cvt_pk_bf16_f32 v27, v14, v15
    s_add_u32 s57, s60, 294912
    s_nop 0
    v_permlane32_swap_b32 v24, v26
    v_permlane32_swap_b32 v25, v27
    s_nop 0
    buffer_store_dwordx4 v[24:27], v249, s[36:39], s57 offen sc1
    v_pk_fma_f32 v[32:33], v[212:213], v[168:169], v[32:33] op_sel_hi:[0,1,1]
    v_pk_fma_f32 v[34:35], v[212:213], v[170:171], v[34:35] op_sel_hi:[0,1,1]
    v_pk_fma_f32 v[36:37], v[216:217], v[168:169], v[36:37] op_sel_hi:[0,1,1]
    v_pk_fma_f32 v[38:39], v[216:217], v[170:171], v[38:39] op_sel_hi:[0,1,1]
    v_pk_mul_f32 v[228:229], v[32:33], v[212:213] op_sel:[0,1] op_sel_hi:[1,1]
    v_pk_mul_f32 v[230:231], v[34:35], v[212:213] op_sel:[0,1] op_sel_hi:[1,1]
    v_pk_mul_f32 v[232:233], v[36:37], v[216:217] op_sel:[0,1] op_sel_hi:[1,1]
    v_pk_mul_f32 v[234:235], v[38:39], v[216:217] op_sel:[0,1] op_sel_hi:[1,1]
    v_exp_f32 v228, v228
    v_exp_f32 v229, v229
    v_exp_f32 v230, v230
    v_exp_f32 v231, v231
    v_exp_f32 v232, v232
    v_exp_f32 v233, v233
    v_exp_f32 v234, v234
    v_exp_f32 v235, v235
    v_pk_fma_f32 v[48:49], v[212:213], v[172:173], v[48:49] op_sel_hi:[0,1,1]
    v_pk_fma_f32 v[50:51], v[212:213], v[174:175], v[50:51] op_sel_hi:[0,1,1]
    v_pk_fma_f32 v[52:53], v[216:217], v[172:173], v[52:53] op_sel_hi:[0,1,1]
    v_pk_fma_f32 v[54:55], v[216:217], v[174:175], v[54:55] op_sel_hi:[0,1,1]
    v_pk_fma_f32 v[228:229], v[228:229], v[214:215], v[214:215] op_sel_hi:[1,0,0]
    v_pk_fma_f32 v[230:231], v[230:231], v[214:215], v[214:215] op_sel_hi:[1,0,0]
    v_pk_fma_f32 v[232:233], v[232:233], v[218:219], v[218:219] op_sel_hi:[1,0,0]
    v_pk_fma_f32 v[234:235], v[234:235], v[218:219], v[218:219] op_sel_hi:[1,0,0]
    v_rcp_f32 v228, v228
    v_rcp_f32 v229, v229
    v_rcp_f32 v230, v230
    v_rcp_f32 v231, v231
    v_rcp_f32 v232, v232
    v_rcp_f32 v233, v233
    v_rcp_f32 v234, v234
    v_rcp_f32 v235, v235
    v_pk_mul_f32 v[32:33], v[32:33], v[48:49]
    v_pk_mul_f32 v[34:35], v[34:35], v[50:51]
    v_pk_mul_f32 v[36:37], v[36:37], v[52:53]
    v_pk_mul_f32 v[38:39], v[38:39], v[54:55]
    v_pk_mul_f32 v[32:33], v[32:33], v[228:229]
    v_pk_mul_f32 v[34:35], v[34:35], v[230:231]
    v_pk_mul_f32 v[36:37], v[36:37], v[232:233]
    v_pk_mul_f32 v[38:39], v[38:39], v[234:235]
    v_cvt_pk_bf16_f32 v48, v32, v33
    v_cvt_pk_bf16_f32 v49, v34, v35
    v_cvt_pk_bf16_f32 v50, v36, v37
    v_cvt_pk_bf16_f32 v51, v38, v39
    s_add_u32 s57, s60, 1024
    s_nop 0
    v_permlane32_swap_b32 v48, v50
    v_permlane32_swap_b32 v49, v51
    s_nop 0
    buffer_store_dwordx4 v[48:51], v249, s[36:39], s57 offen sc1
    v_pk_fma_f32 v[40:41], v[220:221], v[168:169], v[40:41] op_sel_hi:[0,1,1]
    v_pk_fma_f32 v[42:43], v[220:221], v[170:171], v[42:43] op_sel_hi:[0,1,1]
    v_pk_fma_f32 v[44:45], v[224:225], v[168:169], v[44:45] op_sel_hi:[0,1,1]
    v_pk_fma_f32 v[46:47], v[224:225], v[170:171], v[46:47] op_sel_hi:[0,1,1]
    v_pk_mul_f32 v[228:229], v[40:41], v[220:221] op_sel:[0,1] op_sel_hi:[1,1]
    v_pk_mul_f32 v[230:231], v[42:43], v[220:221] op_sel:[0,1] op_sel_hi:[1,1]
    v_pk_mul_f32 v[232:233], v[44:45], v[224:225] op_sel:[0,1] op_sel_hi:[1,1]
    v_pk_mul_f32 v[234:235], v[46:47], v[224:225] op_sel:[0,1] op_sel_hi:[1,1]
    v_exp_f32 v228, v228
    v_exp_f32 v229, v229
    v_exp_f32 v230, v230
    v_exp_f32 v231, v231
    v_exp_f32 v232, v232
    v_exp_f32 v233, v233
    v_exp_f32 v234, v234
    v_exp_f32 v235, v235
    v_pk_fma_f32 v[56:57], v[220:221], v[172:173], v[56:57] op_sel_hi:[0,1,1]
    v_pk_fma_f32 v[58:59], v[220:221], v[174:175], v[58:59] op_sel_hi:[0,1,1]
    v_pk_fma_f32 v[60:61], v[224:225], v[172:173], v[60:61] op_sel_hi:[0,1,1]
    v_pk_fma_f32 v[62:63], v[224:225], v[174:175], v[62:63] op_sel_hi:[0,1,1]
    v_pk_fma_f32 v[228:229], v[228:229], v[222:223], v[222:223] op_sel_hi:[1,0,0]
    v_pk_fma_f32 v[230:231], v[230:231], v[222:223], v[222:223] op_sel_hi:[1,0,0]
    v_pk_fma_f32 v[232:233], v[232:233], v[226:227], v[226:227] op_sel_hi:[1,0,0]
    v_pk_fma_f32 v[234:235], v[234:235], v[226:227], v[226:227] op_sel_hi:[1,0,0]
    v_rcp_f32 v228, v228
    v_rcp_f32 v229, v229
    v_rcp_f32 v230, v230
    v_rcp_f32 v231, v231
    v_rcp_f32 v232, v232
    v_rcp_f32 v233, v233
    v_rcp_f32 v234, v234
    v_rcp_f32 v235, v235
    v_pk_mul_f32 v[40:41], v[40:41], v[56:57]
    v_pk_mul_f32 v[42:43], v[42:43], v[58:59]
    v_pk_mul_f32 v[44:45], v[44:45], v[60:61]
    v_pk_mul_f32 v[46:47], v[46:47], v[62:63]
    v_pk_mul_f32 v[40:41], v[40:41], v[228:229]
    v_pk_mul_f32 v[42:43], v[42:43], v[230:231]
    v_pk_mul_f32 v[44:45], v[44:45], v[232:233]
    v_pk_mul_f32 v[46:47], v[46:47], v[234:235]
    v_cvt_pk_bf16_f32 v56, v40, v41
    v_cvt_pk_bf16_f32 v57, v42, v43
    v_cvt_pk_bf16_f32 v58, v44, v45
    v_cvt_pk_bf16_f32 v59, v46, v47
    s_add_u32 s57, s60, 295936
    s_nop 0
    v_permlane32_swap_b32 v56, v58
    v_permlane32_swap_b32 v57, v59
    s_nop 0
    buffer_store_dwordx4 v[56:59], v249, s[36:39], s57 offen sc1
    v_pk_fma_f32 v[64:65], v[212:213], v[176:177], v[64:65] op_sel_hi:[0,1,1]
    v_pk_fma_f32 v[66:67], v[212:213], v[178:179], v[66:67] op_sel_hi:[0,1,1]
    v_pk_fma_f32 v[68:69], v[216:217], v[176:177], v[68:69] op_sel_hi:[0,1,1]
    v_pk_fma_f32 v[70:71], v[216:217], v[178:179], v[70:71] op_sel_hi:[0,1,1]
    v_pk_mul_f32 v[228:229], v[64:65], v[212:213] op_sel:[0,1] op_sel_hi:[1,1]
    v_pk_mul_f32 v[230:231], v[66:67], v[212:213] op_sel:[0,1] op_sel_hi:[1,1]
    v_pk_mul_f32 v[232:233], v[68:69], v[216:217] op_sel:[0,1] op_sel_hi:[1,1]
    v_pk_mul_f32 v[234:235], v[70:71], v[216:217] op_sel:[0,1] op_sel_hi:[1,1]
    v_exp_f32 v228, v228
    v_exp_f32 v229, v229
    v_exp_f32 v230, v230
    v_exp_f32 v231, v231
    v_exp_f32 v232, v232
    v_exp_f32 v233, v233
    v_exp_f32 v234, v234
    v_exp_f32 v235, v235
    v_pk_fma_f32 v[80:81], v[212:213], v[180:181], v[80:81] op_sel_hi:[0,1,1]
    v_pk_fma_f32 v[82:83], v[212:213], v[182:183], v[82:83] op_sel_hi:[0,1,1]
    v_pk_fma_f32 v[84:85], v[216:217], v[180:181], v[84:85] op_sel_hi:[0,1,1]
    v_pk_fma_f32 v[86:87], v[216:217], v[182:183], v[86:87] op_sel_hi:[0,1,1]
    v_pk_fma_f32 v[228:229], v[228:229], v[214:215], v[214:215] op_sel_hi:[1,0,0]
    v_pk_fma_f32 v[230:231], v[230:231], v[214:215], v[214:215] op_sel_hi:[1,0,0]
    v_pk_fma_f32 v[232:233], v[232:233], v[218:219], v[218:219] op_sel_hi:[1,0,0]
    v_pk_fma_f32 v[234:235], v[234:235], v[218:219], v[218:219] op_sel_hi:[1,0,0]
    v_rcp_f32 v228, v228
    v_rcp_f32 v229, v229
    v_rcp_f32 v230, v230
    v_rcp_f32 v231, v231
    v_rcp_f32 v232, v232
    v_rcp_f32 v233, v233
    v_rcp_f32 v234, v234
    v_rcp_f32 v235, v235
    v_pk_mul_f32 v[64:65], v[64:65], v[80:81]
    v_pk_mul_f32 v[66:67], v[66:67], v[82:83]
    v_pk_mul_f32 v[68:69], v[68:69], v[84:85]
    v_pk_mul_f32 v[70:71], v[70:71], v[86:87]
    v_pk_mul_f32 v[64:65], v[64:65], v[228:229]
    v_pk_mul_f32 v[66:67], v[66:67], v[230:231]
    v_pk_mul_f32 v[68:69], v[68:69], v[232:233]
    v_pk_mul_f32 v[70:71], v[70:71], v[234:235]
    v_cvt_pk_bf16_f32 v80, v64, v65
    v_cvt_pk_bf16_f32 v81, v66, v67
    v_cvt_pk_bf16_f32 v82, v68, v69
    v_cvt_pk_bf16_f32 v83, v70, v71
    s_add_u32 s57, s60, 2048
    s_nop 0
    v_permlane32_swap_b32 v80, v82
    v_permlane32_swap_b32 v81, v83
    s_nop 0
    buffer_store_dwordx4 v[80:83], v249, s[36:39], s57 offen sc1
    v_pk_fma_f32 v[72:73], v[220:221], v[176:177], v[72:73] op_sel_hi:[0,1,1]
    v_pk_fma_f32 v[74:75], v[220:221], v[178:179], v[74:75] op_sel_hi:[0,1,1]
    v_pk_fma_f32 v[76:77], v[224:225], v[176:177], v[76:77] op_sel_hi:[0,1,1]
    v_pk_fma_f32 v[78:79], v[224:225], v[178:179], v[78:79] op_sel_hi:[0,1,1]
    v_pk_mul_f32 v[228:229], v[72:73], v[220:221] op_sel:[0,1] op_sel_hi:[1,1]
    v_pk_mul_f32 v[230:231], v[74:75], v[220:221] op_sel:[0,1] op_sel_hi:[1,1]
    v_pk_mul_f32 v[232:233], v[76:77], v[224:225] op_sel:[0,1] op_sel_hi:[1,1]
    v_pk_mul_f32 v[234:235], v[78:79], v[224:225] op_sel:[0,1] op_sel_hi:[1,1]
    v_exp_f32 v228, v228
    v_exp_f32 v229, v229
    v_exp_f32 v230, v230
    v_exp_f32 v231, v231
    v_exp_f32 v232, v232
    v_exp_f32 v233, v233
    v_exp_f32 v234, v234
    v_exp_f32 v235, v235
    v_pk_fma_f32 v[88:89], v[220:221], v[180:181], v[88:89] op_sel_hi:[0,1,1]
    v_pk_fma_f32 v[90:91], v[220:221], v[182:183], v[90:91] op_sel_hi:[0,1,1]
    v_pk_fma_f32 v[92:93], v[224:225], v[180:181], v[92:93] op_sel_hi:[0,1,1]
    v_pk_fma_f32 v[94:95], v[224:225], v[182:183], v[94:95] op_sel_hi:[0,1,1]
    v_pk_fma_f32 v[228:229], v[228:229], v[222:223], v[222:223] op_sel_hi:[1,0,0]
    v_pk_fma_f32 v[230:231], v[230:231], v[222:223], v[222:223] op_sel_hi:[1,0,0]
    v_pk_fma_f32 v[232:233], v[232:233], v[226:227], v[226:227] op_sel_hi:[1,0,0]
    v_pk_fma_f32 v[234:235], v[234:235], v[226:227], v[226:227] op_sel_hi:[1,0,0]
    v_rcp_f32 v228, v228
    v_rcp_f32 v229, v229
    v_rcp_f32 v230, v230
    v_rcp_f32 v231, v231
    v_rcp_f32 v232, v232
    v_rcp_f32 v233, v233
    v_rcp_f32 v234, v234
    v_rcp_f32 v235, v235
    v_pk_mul_f32 v[72:73], v[72:73], v[88:89]
    v_pk_mul_f32 v[74:75], v[74:75], v[90:91]
    v_pk_mul_f32 v[76:77], v[76:77], v[92:93]
    v_pk_mul_f32 v[78:79], v[78:79], v[94:95]
    v_pk_mul_f32 v[72:73], v[72:73], v[228:229]
    v_pk_mul_f32 v[74:75], v[74:75], v[230:231]
    v_pk_mul_f32 v[76:77], v[76:77], v[232:233]
    v_pk_mul_f32 v[78:79], v[78:79], v[234:235]
    v_cvt_pk_bf16_f32 v88, v72, v73
    v_cvt_pk_bf16_f32 v89, v74, v75
    v_cvt_pk_bf16_f32 v90, v76, v77
    v_cvt_pk_bf16_f32 v91, v78, v79
    s_add_u32 s57, s60, 296960
    s_nop 0
    v_permlane32_swap_b32 v88, v90
    v_permlane32_swap_b32 v89, v91
    s_nop 0
    buffer_store_dwordx4 v[88:91], v249, s[36:39], s57 offen sc1
    v_pk_fma_f32 v[96:97], v[212:213], v[184:185], v[96:97] op_sel_hi:[0,1,1]
    v_pk_fma_f32 v[98:99], v[212:213], v[186:187], v[98:99] op_sel_hi:[0,1,1]
    v_pk_fma_f32 v[100:101], v[216:217], v[184:185], v[100:101] op_sel_hi:[0,1,1]
    v_pk_fma_f32 v[102:103], v[216:217], v[186:187], v[102:103] op_sel_hi:[0,1,1]
    v_pk_mul_f32 v[228:229], v[96:97], v[212:213] op_sel:[0,1] op_sel_hi:[1,1]
    v_pk_mul_f32 v[230:231], v[98:99], v[212:213] op_sel:[0,1] op_sel_hi:[1,1]
    v_pk_mul_f32 v[232:233], v[100:101], v[216:217] op_sel:[0,1] op_sel_hi:[1,1]
    v_pk_mul_f32 v[234:235], v[102:103], v[216:217] op_sel:[0,1] op_sel_hi:[1,1]
    v_exp_f32 v228, v228
    v_exp_f32 v229, v229
    v_exp_f32 v230, v230
    v_exp_f32 v231, v231
    v_exp_f32 v232, v232
    v_exp_f32 v233, v233
    v_exp_f32 v234, v234
    v_exp_f32 v235, v235
    v_pk_fma_f32 v[112:113], v[212:213], v[188:189], v[112:113] op_sel_hi:[0,1,1]
    v_pk_fma_f32 v[114:115], v[212:213], v[190:191], v[114:115] op_sel_hi:[0,1,1]
    v_pk_fma_f32 v[116:117], v[216:217], v[188:189], v[116:117] op_sel_hi:[0,1,1]
    v_pk_fma_f32 v[118:119], v[216:217], v[190:191], v[118:119] op_sel_hi:[0,1,1]
    v_pk_fma_f32 v[228:229], v[228:229], v[214:215], v[214:215] op_sel_hi:[1,0,0]
    v_pk_fma_f32 v[230:231], v[230:231], v[214:215], v[214:215] op_sel_hi:[1,0,0]
    v_pk_fma_f32 v[232:233], v[232:233], v[218:219], v[218:219] op_sel_hi:[1,0,0]
    v_pk_fma_f32 v[234:235], v[234:235], v[218:219], v[218:219] op_sel_hi:[1,0,0]
    v_rcp_f32 v228, v228
    v_rcp_f32 v229, v229
    v_rcp_f32 v230, v230
    v_rcp_f32 v231, v231
    v_rcp_f32 v232, v232
    v_rcp_f32 v233, v233
    v_rcp_f32 v234, v234
    v_rcp_f32 v235, v235
    v_pk_mul_f32 v[96:97], v[96:97], v[112:113]
    v_pk_mul_f32 v[98:99], v[98:99], v[114:115]
    v_pk_mul_f32 v[100:101], v[100:101], v[116:117]
    v_pk_mul_f32 v[102:103], v[102:103], v[118:119]
    v_pk_mul_f32 v[96:97], v[96:97], v[228:229]
    v_pk_mul_f32 v[98:99], v[98:99], v[230:231]
    v_pk_mul_f32 v[100:101], v[100:101], v[232:233]
    v_pk_mul_f32 v[102:103], v[102:103], v[234:235]
    v_cvt_pk_bf16_f32 v112, v96, v97
    v_cvt_pk_bf16_f32 v113, v98, v99
    v_cvt_pk_bf16_f32 v114, v100, v101
    v_cvt_pk_bf16_f32 v115, v102, v103
    s_add_u32 s57, s60, 3072
    s_nop 0
    v_permlane32_swap_b32 v112, v114
    v_permlane32_swap_b32 v113, v115
    s_nop 0
    buffer_store_dwordx4 v[112:115], v249, s[36:39], s57 offen sc1
    v_pk_fma_f32 v[104:105], v[220:221], v[184:185], v[104:105] op_sel_hi:[0,1,1]
    v_pk_fma_f32 v[106:107], v[220:221], v[186:187], v[106:107] op_sel_hi:[0,1,1]
    v_pk_fma_f32 v[108:109], v[224:225], v[184:185], v[108:109] op_sel_hi:[0,1,1]
    v_pk_fma_f32 v[110:111], v[224:225], v[186:187], v[110:111] op_sel_hi:[0,1,1]
    v_pk_mul_f32 v[228:229], v[104:105], v[220:221] op_sel:[0,1] op_sel_hi:[1,1]
    v_pk_mul_f32 v[230:231], v[106:107], v[220:221] op_sel:[0,1] op_sel_hi:[1,1]
    v_pk_mul_f32 v[232:233], v[108:109], v[224:225] op_sel:[0,1] op_sel_hi:[1,1]
    v_pk_mul_f32 v[234:235], v[110:111], v[224:225] op_sel:[0,1] op_sel_hi:[1,1]
    v_exp_f32 v228, v228
    v_exp_f32 v229, v229
    v_exp_f32 v230, v230
    v_exp_f32 v231, v231
    v_exp_f32 v232, v232
    v_exp_f32 v233, v233
    v_exp_f32 v234, v234
    v_exp_f32 v235, v235
    v_pk_fma_f32 v[120:121], v[220:221], v[188:189], v[120:121] op_sel_hi:[0,1,1]
    v_pk_fma_f32 v[122:123], v[220:221], v[190:191], v[122:123] op_sel_hi:[0,1,1]
    v_pk_fma_f32 v[124:125], v[224:225], v[188:189], v[124:125] op_sel_hi:[0,1,1]
    v_pk_fma_f32 v[126:127], v[224:225], v[190:191], v[126:127] op_sel_hi:[0,1,1]
    v_pk_fma_f32 v[228:229], v[228:229], v[222:223], v[222:223] op_sel_hi:[1,0,0]
    v_pk_fma_f32 v[230:231], v[230:231], v[222:223], v[222:223] op_sel_hi:[1,0,0]
    v_pk_fma_f32 v[232:233], v[232:233], v[226:227], v[226:227] op_sel_hi:[1,0,0]
    v_pk_fma_f32 v[234:235], v[234:235], v[226:227], v[226:227] op_sel_hi:[1,0,0]
    v_rcp_f32 v228, v228
    v_rcp_f32 v229, v229
    v_rcp_f32 v230, v230
    v_rcp_f32 v231, v231
    v_rcp_f32 v232, v232
    v_rcp_f32 v233, v233
    v_rcp_f32 v234, v234
    v_rcp_f32 v235, v235
    v_pk_mul_f32 v[104:105], v[104:105], v[120:121]
    v_pk_mul_f32 v[106:107], v[106:107], v[122:123]
    v_pk_mul_f32 v[108:109], v[108:109], v[124:125]
    v_pk_mul_f32 v[110:111], v[110:111], v[126:127]
    v_pk_mul_f32 v[104:105], v[104:105], v[228:229]
    v_pk_mul_f32 v[106:107], v[106:107], v[230:231]
    v_pk_mul_f32 v[108:109], v[108:109], v[232:233]
    v_pk_mul_f32 v[110:111], v[110:111], v[234:235]
    v_cvt_pk_bf16_f32 v120, v104, v105
    v_cvt_pk_bf16_f32 v121, v106, v107
    v_cvt_pk_bf16_f32 v122, v108, v109
    v_cvt_pk_bf16_f32 v123, v110, v111
    s_add_u32 s57, s60, 297984
    s_nop 0
    v_permlane32_swap_b32 v120, v122
    v_permlane32_swap_b32 v121, v123
    s_nop 0
    buffer_store_dwordx4 v[120:123], v249, s[36:39], s57 offen sc1
    s_cmp_eq_u32 s44, 1
    s_cbranch_scc1 K1_QT
    v_pk_fma_f32 v[128:129], v[212:213], v[192:193], v[128:129] op_sel_hi:[0,1,1]
    v_pk_fma_f32 v[130:131], v[212:213], v[194:195], v[130:131] op_sel_hi:[0,1,1]
    v_pk_fma_f32 v[132:133], v[216:217], v[192:193], v[132:133] op_sel_hi:[0,1,1]
    v_pk_fma_f32 v[134:135], v[216:217], v[194:195], v[134:135] op_sel_hi:[0,1,1]
    v_pk_mul_f32 v[228:229], v[128:129], v[212:213] op_sel:[0,1] op_sel_hi:[1,1]
    v_pk_mul_f32 v[230:231], v[130:131], v[212:213] op_sel:[0,1] op_sel_hi:[1,1]
    v_pk_mul_f32 v[232:233], v[132:133], v[216:217] op_sel:[0,1] op_sel_hi:[1,1]
    v_pk_mul_f32 v[234:235], v[134:135], v[216:217] op_sel:[0,1] op_sel_hi:[1,1]
    v_exp_f32 v228, v228
    v_exp_f32 v229, v229
    v_exp_f32 v230, v230
    v_exp_f32 v231, v231
    v_exp_f32 v232, v232
    v_exp_f32 v233, v233
    v_exp_f32 v234, v234
    v_exp_f32 v235, v235
    v_pk_fma_f32 v[144:145], v[212:213], v[196:197], v[144:145] op_sel_hi:[0,1,1]
    v_pk_fma_f32 v[146:147], v[212:213], v[198:199], v[146:147] op_sel_hi:[0,1,1]
    v_pk_fma_f32 v[148:149], v[216:217], v[196:197], v[148:149] op_sel_hi:[0,1,1]
    v_pk_fma_f32 v[150:151], v[216:217], v[198:199], v[150:151] op_sel_hi:[0,1,1]
    v_pk_fma_f32 v[228:229], v[228:229], v[214:215], v[214:215] op_sel_hi:[1,0,0]
    v_pk_fma_f32 v[230:231], v[230:231], v[214:215], v[214:215] op_sel_hi:[1,0,0]
    v_pk_fma_f32 v[232:233], v[232:233], v[218:219], v[218:219] op_sel_hi:[1,0,0]
    v_pk_fma_f32 v[234:235], v[234:235], v[218:219], v[218:219] op_sel_hi:[1,0,0]
    v_rcp_f32 v228, v228
    v_rcp_f32 v229, v229
    v_rcp_f32 v230, v230
    v_rcp_f32 v231, v231
    v_rcp_f32 v232, v232
    v_rcp_f32 v233, v233
    v_rcp_f32 v234, v234
    v_rcp_f32 v235, v235
    v_pk_mul_f32 v[128:129], v[128:129], v[144:145]
    v_pk_mul_f32 v[130:131], v[130:131], v[146:147]
    v_pk_mul_f32 v[132:133], v[132:133], v[148:149]
    v_pk_mul_f32 v[134:135], v[134:135], v[150:151]
    v_pk_mul_f32 v[128:129], v[128:129], v[228:229]
    v_pk_mul_f32 v[130:131], v[130:131], v[230:231]
    v_pk_mul_f32 v[132:133], v[132:133], v[232:233]
    v_pk_mul_f32 v[134:135], v[134:135], v[234:235]
    v_cvt_pk_bf16_f32 v144, v128, v129
    v_cvt_pk_bf16_f32 v145, v130, v131
    v_cvt_pk_bf16_f32 v146, v132, v133
    v_cvt_pk_bf16_f32 v147, v134, v135
    s_add_u32 s57, s60, 4096
    s_nop 0
    v_permlane32_swap_b32 v144, v146
    v_permlane32_swap_b32 v145, v147
    s_nop 0
    buffer_store_dwordx4 v[144:147], v249, s[36:39], s57 offen sc1
    v_pk_fma_f32 v[136:137], v[220:221], v[192:193], v[136:137] op_sel_hi:[0,1,1]
    v_pk_fma_f32 v[138:139], v[220:221], v[194:195], v[138:139] op_sel_hi:[0,1,1]
    v_pk_fma_f32 v[140:141], v[224:225], v[192:193], v[140:141] op_sel_hi:[0,1,1]
    v_pk_fma_f32 v[142:143], v[224:225], v[194:195], v[142:143] op_sel_hi:[0,1,1]
    v_pk_mul_f32 v[228:229], v[136:137], v[220:221] op_sel:[0,1] op_sel_hi:[1,1]
    v_pk_mul_f32 v[230:231], v[138:139], v[220:221] op_sel:[0,1] op_sel_hi:[1,1]
    v_pk_mul_f32 v[232:233], v[140:141], v[224:225] op_sel:[0,1] op_sel_hi:[1,1]
    v_pk_mul_f32 v[234:235], v[142:143], v[224:225] op_sel:[0,1] op_sel_hi:[1,1]
    v_exp_f32 v228, v228
    v_exp_f32 v229, v229
    v_exp_f32 v230, v230
    v_exp_f32 v231, v231
    v_exp_f32 v232, v232
    v_exp_f32 v233, v233
    v_exp_f32 v234, v234
    v_exp_f32 v235, v235
    v_pk_fma_f32 v[152:153], v[220:221], v[196:197], v[152:153] op_sel_hi:[0,1,1]
    v_pk_fma_f32 v[154:155], v[220:221], v[198:199], v[154:155] op_sel_hi:[0,1,1]
    v_pk_fma_f32 v[156:157], v[224:225], v[196:197], v[156:157] op_sel_hi:[0,1,1]
    v_pk_fma_f32 v[158:159], v[224:225], v[198:199], v[158:159] op_sel_hi:[0,1,1]
    v_pk_fma_f32 v[228:229], v[228:229], v[222:223], v[222:223] op_sel_hi:[1,0,0]
    v_pk_fma_f32 v[230:231], v[230:231], v[222:223], v[222:223] op_sel_hi:[1,0,0]
    v_pk_fma_f32 v[232:233], v[232:233], v[226:227], v[226:227] op_sel_hi:[1,0,0]
    v_pk_fma_f32 v[234:235], v[234:235], v[226:227], v[226:227] op_sel_hi:[1,0,0]
    v_rcp_f32 v228, v228
    v_rcp_f32 v229, v229
    v_rcp_f32 v230, v230
    v_rcp_f32 v231, v231
    v_rcp_f32 v232, v232
    v_rcp_f32 v233, v233
    v_rcp_f32 v234, v234
    v_rcp_f32 v235, v235
    v_pk_mul_f32 v[136:137], v[136:137], v[152:153]
    v_pk_mul_f32 v[138:139], v[138:139], v[154:155]
    v_pk_mul_f32 v[140:141], v[140:141], v[156:157]
    v_pk_mul_f32 v[142:143], v[142:143], v[158:159]
    v_pk_mul_f32 v[136:137], v[136:137], v[228:229]
    v_pk_mul_f32 v[138:139], v[138:139], v[230:231]
    v_pk_mul_f32 v[140:141], v[140:141], v[232:233]
    v_pk_mul_f32 v[142:143], v[142:143], v[234:235]
    v_cvt_pk_bf16_f32 v152, v136, v137
    v_cvt_pk_bf16_f32 v153, v138, v139
    v_cvt_pk_bf16_f32 v154, v140, v141
    v_cvt_pk_bf16_f32 v155, v142, v143
    s_add_u32 s57, s60, 299008
    s_nop 0
    v_permlane32_swap_b32 v152, v154
    v_permlane32_swap_b32 v153, v155
    s_nop 0
    buffer_store_dwordx4 v[152:155], v249, s[36:39], s57 offen sc1
    s_branch K1_END
K1_QT:
    s_lshl_b32 s57, s40, 6
    s_add_u32 s62, s57, s61
    v_lshlrev_b32 v248, 2, v246
    v_fma_f32 v128, v212, v192, v128
    v_fma_f32 v144, v212, v196, v144
    v_fma_f32 v129, v212, v193, v129
    v_fma_f32 v145, v212, v197, v145
    v_fma_f32 v130, v212, v194, v130
    v_fma_f32 v146, v212, v198, v146
    v_fma_f32 v131, v212, v195, v131
    v_fma_f32 v147, v212, v199, v147
    v_mul_f32 v228, 0x3eae1a93, v215
    v_mul_f32 v128, v128, v228
    v_mul_f32 v129, v129, v228
    v_mul_f32 v130, v130, v228
    v_mul_f32 v131, v131, v228
    v_mul_f32 v230, v144, v228
    v_mul_f32 v231, v145, v228
    v_mul_f32 v144, v144, v215
    v_mul_f32 v145, v145, v215
    v_mul_f32 v146, v146, v215
    v_mul_f32 v147, v147, v215
    v_cvt_pk_bf16_f32 v232, v230, v231
    v_cvt_pk_bf16_f32 v144, v144, v144
    v_cvt_pk_bf16_f32 v145, v145, v145
    v_cvt_pk_bf16_f32 v146, v146, v146
    v_cvt_pk_bf16_f32 v147, v147, v147
    v_fma_f32 v132, v216, v192, v132
    v_fma_f32 v148, v216, v196, v148
    v_fma_f32 v133, v216, v193, v133
    v_fma_f32 v149, v216, v197, v149
    v_fma_f32 v134, v216, v194, v134
    v_fma_f32 v150, v216, v198, v150
    v_fma_f32 v135, v216, v195, v135
    v_fma_f32 v151, v216, v199, v151
    v_mul_f32 v228, 0x3eae1a93, v219
    v_mul_f32 v132, v132, v228
    v_mul_f32 v133, v133, v228
    v_mul_f32 v134, v134, v228
    v_mul_f32 v135, v135, v228
    v_mul_f32 v230, v148, v228
    v_mul_f32 v231, v149, v228
    v_mul_f32 v148, v148, v219
    v_mul_f32 v149, v149, v219
    v_mul_f32 v150, v150, v219
    v_mul_f32 v151, v151, v219
    v_cvt_pk_bf16_f32 v233, v230, v231
    v_cvt_pk_bf16_f32 v148, v148, v148
    v_cvt_pk_bf16_f32 v149, v149, v149
    v_cvt_pk_bf16_f32 v150, v150, v150
    v_cvt_pk_bf16_f32 v151, v151, v151
    v_fma_f32 v136, v220, v192, v136
    v_fma_f32 v152, v220, v196, v152
    v_fma_f32 v137, v220, v193, v137
    v_fma_f32 v153, v220, v197, v153
    v_fma_f32 v138, v220, v194, v138
    v_fma_f32 v154, v220, v198, v154
    v_fma_f32 v139, v220, v195, v139
    v_fma_f32 v155, v220, v199, v155
    v_mul_f32 v228, 0x3eae1a93, v223
    v_mul_f32 v136, v136, v228
    v_mul_f32 v137, v137, v228
    v_mul_f32 v138, v138, v228
    v_mul_f32 v139, v139, v228
    v_mul_f32 v230, v152, v228
    v_mul_f32 v231, v153, v228
    v_mul_f32 v152, v152, v223
    v_mul_f32 v153, v153, v223
    v_mul_f32 v154, v154, v223
    v_mul_f32 v155, v155, v223
    v_cvt_pk_bf16_f32 v234, v230, v231
    v_cvt_pk_bf16_f32 v152, v152, v152
    v_cvt_pk_bf16_f32 v153, v153, v153
    v_cvt_pk_bf16_f32 v154, v154, v154
    v_cvt_pk_bf16_f32 v155, v155, v155
    v_fma_f32 v140, v224, v192, v140
    v_fma_f32 v156, v224, v196, v156
    v_fma_f32 v141, v224, v193, v141
    v_fma_f32 v157, v224, v197, v157
    v_fma_f32 v142, v224, v194, v142
    v_fma_f32 v158, v224, v198, v158
    v_fma_f32 v143, v224, v195, v143
    v_fma_f32 v159, v224, v199, v159
    v_mul_f32 v228, 0x3eae1a93, v227
    v_mul_f32 v140, v140, v228
    v_mul_f32 v141, v141, v228
    v_mul_f32 v142, v142, v228
    v_mul_f32 v143, v143, v228
    v_mul_f32 v230, v156, v228
    v_mul_f32 v231, v157, v228
    v_mul_f32 v156, v156, v227
    v_mul_f32 v157, v157, v227
    v_mul_f32 v158, v158, v227
    v_mul_f32 v159, v159, v227
    v_cvt_pk_bf16_f32 v235, v230, v231
    v_cvt_pk_bf16_f32 v156, v156, v156
    v_cvt_pk_bf16_f32 v157, v157, v157
    v_cvt_pk_bf16_f32 v158, v158, v158
    v_cvt_pk_bf16_f32 v159, v159, v159
    v_cvt_pk_bf16_f32 v200, v128, v129
    v_cvt_pk_bf16_f32 v201, v130, v131
    v_cvt_pk_bf16_f32 v202, v132, v133
    v_cvt_pk_bf16_f32 v203, v134, v135
    s_lshl_b32 s57, s62, 10
    s_add_u32 s57, s57, 18874368
    v_permlane32_swap_b32 v200, v202
    v_permlane32_swap_b32 v201, v203
    s_nop 0
    buffer_store_dwordx4 v[200:203], v249, s[36:39], s57 offen sc1
    v_cvt_pk_bf16_f32 v204, v136, v137
    v_cvt_pk_bf16_f32 v205, v138, v139
    v_cvt_pk_bf16_f32 v206, v140, v141
    v_cvt_pk_bf16_f32 v207, v142, v143
    s_lshl_b32 s57, s62, 10
    s_add_u32 s57, s57, 18875392
    v_permlane32_swap_b32 v204, v206
    v_permlane32_swap_b32 v205, v207
    s_nop 0
    buffer_store_dwordx4 v[204:207], v249, s[36:39], s57 offen sc1
    s_lshl_b32 s57, s62, 7
    s_add_u32 s57, s57, 20971520
    s_mov_b64 exec, 0xffff
    buffer_store_dword v232, v248, s[36:39], s57 offen offset:0
    buffer_store_dword v233, v248, s[36:39], s57 offen offset:64
    buffer_store_dword v234, v248, s[36:39], s57 offen offset:128
    buffer_store_dword v235, v248, s[36:39], s57 offen offset:192
    s_mov_b64 exec, -1
    s_cmp_ge_u32 s40, 6
    s_cbranch_scc1 K1_END
    s_mul_i32 s63, s41, 20480
    s_add_u32 s63, s63, 21233664
    s_lshl_b32 s57, s43, 11
    v_lshl_add_u32 v208, v246, 4, s57
    s_lshl_b32 s57, s43, 8
    v_lshl_add_u32 v209, v246, 2, s57
    v_bfe_u32 v210, v246, 2, 1
    v_mul_u32_u24 v210, 288, v210
    v_bfe_u32 v211, v246, 3, 1
    v_lshl_add_u32 v210, v211, 3, v210
    v_and_b32 v211, 3, v246
    v_lshl_add_u32 v210, v211, 1, v210
    s_mul_i32 s57, s43, 2560
    v_add_u32 v210, s57, v210
    s_cmp_lg_u32 s40, 0
    s_cbranch_scc1 K1_KV1
    s_mov_b32 exec_lo, 0xffff0000
    s_mov_b32 exec_hi, 0
    s_add_u32 s57, s63, 0
    buffer_store_short v144, v208, s[36:39], s57 offen offset:0
    buffer_store_short v148, v208, s[36:39], s57 offen offset:256
    buffer_store_short v152, v208, s[36:39], s57 offen offset:1024
    buffer_store_short v156, v208, s[36:39], s57 offen offset:1280
    s_add_u32 s57, s63, 2
    buffer_store_short v145, v208, s[36:39], s57 offen offset:0
    buffer_store_short v149, v208, s[36:39], s57 offen offset:256
    buffer_store_short v153, v208, s[36:39], s57 offen offset:1024
    buffer_store_short v157, v208, s[36:39], s57 offen offset:1280
    s_add_u32 s57, s63, 4
    buffer_store_short v146, v208, s[36:39], s57 offen offset:0
    buffer_store_short v150, v208, s[36:39], s57 offen offset:256
    buffer_store_short v154, v208, s[36:39], s57 offen offset:1024
    buffer_store_short v158, v208, s[36:39], s57 offen offset:1280
    s_add_u32 s57, s63, 6
    buffer_store_short v147, v208, s[36:39], s57 offen offset:0
    buffer_store_short v151, v208, s[36:39], s57 offen offset:256
    buffer_store_short v155, v208, s[36:39], s57 offen offset:1024
    buffer_store_short v159, v208, s[36:39], s57 offen offset:1280
    s_mov_b32 exec_lo, 0
    s_mov_b32 exec_hi, 0xffff
    s_add_u32 s57, s63, 512
    buffer_store_short v144, v208, s[36:39], s57 offen offset:0
    buffer_store_short v148, v208, s[36:39], s57 offen offset:256
    buffer_store_short v152, v208, s[36:39], s57 offen offset:1024
    buffer_store_short v156, v208, s[36:39], s57 offen offset:1280
    s_add_u32 s57, s63, 514
    buffer_store_short v145, v208, s[36:39], s57 offen offset:0
    buffer_store_short v149, v208, s[36:39], s57 offen offset:256
    buffer_store_short v153, v208, s[36:39], s57 offen offset:1024
    buffer_store_short v157, v208, s[36:39], s57 offen offset:1280
    s_branch K1_END
K1_KV1:
    s_cmp_lg_u32 s40, 1
    s_cbranch_scc1 K1_KV2
    s_mov_b32 exec_lo, 0xffff0000
    s_mov_b32 exec_hi, 0
    s_add_u32 s57, s63, 516
    buffer_store_short v144, v208, s[36:39], s57 offen offset:0
    buffer_store_short v148, v208, s[36:39], s57 offen offset:256
    buffer_store_short v152, v208, s[36:39], s57 offen offset:1024
    buffer_store_short v156, v208, s[36:39], s57 offen offset:1280
    s_add_u32 s57, s63, 518
    buffer_store_short v145, v208, s[36:39], s57 offen offset:0
    buffer_store_short v149, v208, s[36:39], s57 offen offset:256
    buffer_store_short v153, v208, s[36:39], s57 offen offset:1024
    buffer_store_short v157, v208, s[36:39], s57 offen offset:1280
    s_add_u32 s57, s63, 8
    buffer_store_short v146, v208, s[36:39], s57 offen offset:0
    buffer_store_short v150, v208, s[36:39], s57 offen offset:256
    buffer_store_short v154, v208, s[36:39], s57 offen offset:1024
    buffer_store_short v158, v208, s[36:39], s57 offen offset:1280
    s_add_u32 s57, s63, 10
    buffer_store_short v147, v208, s[36:39], s57 offen offset:0
    buffer_store_short v151, v208, s[36:39], s57 offen offset:256
    buffer_store_short v155, v208, s[36:39], s57 offen offset:1024
    buffer_store_short v159, v208, s[36:39], s57 offen offset:1280
    s_mov_b32 exec_lo, 0
    s_mov_b32 exec_hi, 0xffff
    s_add_u32 s57, s63, 12
    buffer_store_short v144, v208, s[36:39], s57 offen offset:0
    buffer_store_short v148, v208, s[36:39], s57 offen offset:256
    buffer_store_short v152, v208, s[36:39], s57 offen offset:1024
    buffer_store_short v156, v208, s[36:39], s57 offen offset:1280
    s_add_u32 s57, s63, 14
    buffer_store_short v145, v208, s[36:39], s57 offen offset:0
    buffer_store_short v149, v208, s[36:39], s57 offen offset:256
    buffer_store_short v153, v208, s[36:39], s57 offen offset:1024
    buffer_store_short v157, v208, s[36:39], s57 offen offset:1280
    s_branch K1_END
K1_KV2:
    s_cmp_lg_u32 s40, 2
    s_cbranch_scc1 K1_KV3
    s_mov_b32 exec_lo, 0xffff0000
    s_mov_b32 exec_hi, 0
    s_add_u32 s57, s63, 520
    buffer_store_short v144, v208, s[36:39], s57 offen offset:0
    buffer_store_short v148, v208, s[36:39], s57 offen offset:256
    buffer_store_short v152, v208, s[36:39], s57 offen offset:1024
    buffer_store_short v156, v208, s[36:39], s57 offen offset:1280
    s_add_u32 s57, s63, 522
    buffer_store_short v145, v208, s[36:39], s57 offen offset:0
    buffer_store_short v149, v208, s[36:39], s57 offen offset:256
    buffer_store_short v153, v208, s[36:39], s57 offen offset:1024
    buffer_store_short v157, v208, s[36:39], s57 offen offset:1280
    s_add_u32 s57, s63, 524
    buffer_store_short v146, v208, s[36:39], s57 offen offset:0
    buffer_store_short v150, v208, s[36:39], s57 offen offset:256
    buffer_store_short v154, v208, s[36:39], s57 offen offset:1024
    buffer_store_short v158, v208, s[36:39], s57 offen offset:1280
    s_add_u32 s57, s63, 526
    buffer_store_short v147, v208, s[36:39], s57 offen offset:0
    buffer_store_short v151, v208, s[36:39], s57 offen offset:256
    buffer_store_short v155, v208, s[36:39], s57 offen offset:1024
    buffer_store_short v159, v208, s[36:39], s57 offen offset:1280
    s_mov_b32 exec_lo, 0
    s_mov_b32 exec_hi, 0xffff
    s_add_u32 s57, s63, 18432
    buffer_store_short v144, v209, s[36:39], s57 offen offset:0
    buffer_store_short v148, v209, s[36:39], s57 offen offset:64
    buffer_store_short v152, v209, s[36:39], s57 offen offset:128
    buffer_store_short v156, v209, s[36:39], s57 offen offset:192
    s_add_u32 s57, s63, 18434
    buffer_store_short v145, v209, s[36:39], s57 offen offset:0
    buffer_store_short v149, v209, s[36:39], s57 offen offset:64
    buffer_store_short v153, v209, s[36:39], s57 offen offset:128
    buffer_store_short v157, v209, s[36:39], s57 offen offset:192
    s_branch K1_END
K1_KV3:
    s_cmp_lg_u32 s40, 3
    s_cbranch_scc1 K1_KV4
    s_mov_b32 exec_lo, 0xffff0000
    s_mov_b32 exec_hi, 0
    s_add_u32 s57, s63, 8192
    buffer_store_short v144, v210, s[36:39], s57 offen offset:0
    buffer_store_short v148, v210, s[36:39], s57 offen offset:640
    buffer_store_short v152, v210, s[36:39], s57 offen offset:1280
    buffer_store_short v156, v210, s[36:39], s57 offen offset:1920
    s_add_u32 s57, s63, 8208
    buffer_store_short v145, v210, s[36:39], s57 offen offset:0
    buffer_store_short v149, v210, s[36:39], s57 offen offset:640
    buffer_store_short v153, v210, s[36:39], s57 offen offset:1280
    buffer_store_short v157, v210, s[36:39], s57 offen offset:1920
    s_add_u32 s57, s63, 8224
    buffer_store_short v146, v210, s[36:39], s57 offen offset:0
    buffer_store_short v150, v210, s[36:39], s57 offen offset:640
    buffer_store_short v154, v210, s[36:39], s57 offen offset:1280
    buffer_store_short v158, v210, s[36:39], s57 offen offset:1920
    s_add_u32 s57, s63, 8240
    buffer_store_short v147, v210, s[36:39], s57 offen offset:0
    buffer_store_short v151, v210, s[36:39], s57 offen offset:640
    buffer_store_short v155, v210, s[36:39], s57 offen offset:1280
    buffer_store_short v159, v210, s[36:39], s57 offen offset:1920
    s_mov_b32 exec_lo, 0
    s_mov_b32 exec_hi, 0xffff
    s_add_u32 s57, s63, 8256
    buffer_store_short v144, v210, s[36:39], s57 offen offset:0
    buffer_store_short v148, v210, s[36:39], s57 offen offset:640
    buffer_store_short v152, v210, s[36:39], s57 offen offset:1280
    buffer_store_short v156, v210, s[36:39], s57 offen offset:1920
    s_add_u32 s57, s63, 8272
    buffer_store_short v145, v210, s[36:39], s57 offen offset:0
    buffer_store_short v149, v210, s[36:39], s57 offen offset:640
    buffer_store_short v153, v210, s[36:39], s57 offen offset:1280
    buffer_store_short v157, v210, s[36:39], s57 offen offset:1920
    s_mov_b64 exec, 15
    v_mul_u32_u24 v208, 640, v255
    s_mul_i32 s57, s43, 2560
    s_add_u32 s57, s57, s63
    s_add_u32 s57, s57, 8768
    v_mov_b32 v128, 0x3f803f80
    v_mov_b32 v132, 0
    v_mov_b32 v129, 0x3f803f80
    v_mov_b32 v133, 0
    v_mov_b32 v130, 0x3f803f80
    v_mov_b32 v134, 0
    v_mov_b32 v131, 0x3f803f80
    v_mov_b32 v135, 0
    buffer_store_dwordx4 v[128:131], v208, s[36:39], s57 offen
    buffer_store_dwordx4 v[132:135], v208, s[36:39], s57 offen offset:16
    s_branch K1_END
K1_KV4:
    s_cmp_lg_u32 s40, 4
    s_cbranch_scc1 K1_KV5
    s_mov_b32 exec_lo, 0xffff0000
    s_mov_b32 exec_hi, 0
    s_add_u32 s57, s63, 8288
    buffer_store_short v144, v210, s[36:39], s57 offen offset:0
    buffer_store_short v148, v210, s[36:39], s57 offen offset:640
    buffer_store_short v152, v210, s[36:39], s57 offen offset:1280
    buffer_store_short v156, v210, s[36:39], s57 offen offset:1920
    s_add_u32 s57, s63, 8304
    buffer_store_short v145, v210, s[36:39], s57 offen offset:0
    buffer_store_short v149, v210, s[36:39], s57 offen offset:640
    buffer_store_short v153, v210, s[36:39], s57 offen offset:1280
    buffer_store_short v157, v210, s[36:39], s57 offen offset:1920
    s_add_u32 s57, s63, 8320
    buffer_store_short v146, v210, s[36:39], s57 offen offset:0
    buffer_store_short v150, v210, s[36:39], s57 offen offset:640
    buffer_store_short v154, v210, s[36:39], s57 offen offset:1280
    buffer_store_short v158, v210, s[36:39], s57 offen offset:1920
    s_add_u32 s57, s63, 8336
    buffer_store_short v147, v210, s[36:39], s57 offen offset:0
    buffer_store_short v151, v210, s[36:39], s57 offen offset:640
    buffer_store_short v155, v210, s[36:39], s57 offen offset:1280
    buffer_store_short v159, v210, s[36:39], s57 offen offset:1920
    s_mov_b32 exec_lo, 0
    s_mov_b32 exec_hi, 0xffff
    s_add_u32 s57, s63, 8352
    buffer_store_short v144, v210, s[36:39], s57 offen offset:0
    buffer_store_short v148, v210, s[36:39], s57 offen offset:640
    buffer_store_short v152, v210, s[36:39], s57 offen offset:1280
    buffer_store_short v156, v210, s[36:39], s57 offen offset:1920
    s_add_u32 s57, s63, 8368
    buffer_store_short v145, v210, s[36:39], s57 offen offset:0
    buffer_store_short v149, v210, s[36:39], s57 offen offset:640
    buffer_store_short v153, v210, s[36:39], s57 offen offset:1280
    buffer_store_short v157, v210, s[36:39], s57 offen offset:1920
    s_branch K1_END
K1_KV5:
    s_cmp_lg_u32 s40, 5
    s_cbranch_scc1 K1_KV6
    s_mov_b32 exec_lo, 0xffff0000
    s_mov_b32 exec_hi, 0
    s_add_u32 s57, s63, 8384
    buffer_store_short v144, v210, s[36:39], s57 offen offset:0
    buffer_store_short v148, v210, s[36:39], s57 offen offset:640
    buffer_store_short v152, v210, s[36:39], s57 offen offset:1280
    buffer_store_short v156, v210, s[36:39], s57 offen offset:1920
    s_add_u32 s57, s63, 8400
    buffer_store_short v145, v210, s[36:39], s57 offen offset:0
    buffer_store_short v149, v210, s[36:39], s57 offen offset:640
    buffer_store_short v153, v210, s[36:39], s57 offen offset:1280
    buffer_store_short v157, v210, s[36:39], s57 offen offset:1920
    s_add_u32 s57, s63, 8416
    buffer_store_short v146, v210, s[36:39], s57 offen offset:0
    buffer_store_short v150, v210, s[36:39], s57 offen offset:640
    buffer_store_short v154, v210, s[36:39], s57 offen offset:1280
    buffer_store_short v158, v210, s[36:39], s57 offen offset:1920
    s_add_u32 s57, s63, 8432
    buffer_store_short v147, v210, s[36:39], s57 offen offset:0
    buffer_store_short v151, v210, s[36:39], s57 offen offset:640
    buffer_store_short v155, v210, s[36:39], s57 offen offset:1280
    buffer_store_short v159, v210, s[36:39], s57 offen offset:1920
    s_mov_b32 exec_lo, 0
    s_mov_b32 exec_hi, 0xffff
    s_add_u32 s57, s63, 8448
    buffer_store_short v144, v210, s[36:39], s57 offen offset:0
    buffer_store_short v148, v210, s[36:39], s57 offen offset:640
    buffer_store_short v152, v210, s[36:39], s57 offen offset:1280
    buffer_store_short v156, v210, s[36:39], s57 offen offset:1920
    s_add_u32 s57, s63, 8464
    buffer_store_short v145, v210, s[36:39], s57 offen offset:0
    buffer_store_short v149, v210, s[36:39], s57 offen offset:640
    buffer_store_short v153, v210, s[36:39], s57 offen offset:1280
    buffer_store_short v157, v210, s[36:39], s57 offen offset:1920
    s_branch K1_END
K1_KV6:
K1_END:
K1_EXIT:
    s_endpgm
K1_SLOW:
    s_waitcnt vmcnt(0) lgkmcnt(0)
    s_barrier
    s_cmp_lg_u32 s42, 0
    s_cbranch_scc1 K1_POLLED
    v_lshlrev_b32 v246, 2, v255
    s_mov_b32 s50, 64
K1_POLL:
    s_cmp_eq_u32 s50, 0
    s_cbranch_scc1 K1_POLLED
    s_sub_u32 s50, s50, 1
    buffer_load_dword v245, v246, s[64:67], 0 offen sc1
    s_waitcnt vmcnt(0)
    v_cmp_ne_u32 vcc, 0x01010101, v245
    s_nop 4
    s_cmp_eq_u64 vcc, 0
    s_cbranch_scc0 K1_POLL
    v_mov_b32 v246, 81152
    v_mov_b32 v247, 0
    ds_write_b32 v246, v247
    s_waitcnt lgkmcnt(0)
K1_POLLED:
    s_barrier
    v_mov_b32 v246, 81152
    ds_read_b32 v247, v246
    s_waitcnt lgkmcnt(0)
    v_readfirstlane_b32 s57, v247
    s_cmp_lg_u32 s57, 0
    s_cbranch_scc1 K1_SLOW2
    v_and_b32 v251, 15, v255
    v_lshlrev_b32 v251, 4, v251
    v_lshlrev_b32 v252, 2, v255
    s_lshl_b32 s63, s41, 12
    s_lshl_b32 s58, s43, 10
    s_add_u32 s63, s63, s58
    s_add_u32 s63, s63, 44040192
    s_mul_i32 s47, s40, 10240
    s_lshl_b32 s58, s42, 8
    s_add_u32 s47, s47, s58
    s_add_u32 s47, s47, 44105728
    s_cmp_ge_u32 s42, 5
    s_cselect_b32 s47, 0x70000000, s47
    buffer_load_dwordx4 v[212:215], v251, s[36:39], s63 offen offset:0 sc1
    buffer_load_dwordx4 v[216:219], v251, s[36:39], s63 offen offset:256 sc1
    buffer_load_dwordx4 v[220:223], v251, s[36:39], s63 offen offset:512 sc1
    buffer_load_dwordx4 v[224:227], v251, s[36:39], s63 offen offset:768 sc1
    buffer_load_dword v228, v252, s[36:39], s47 offen offset:0 sc1
    buffer_load_dword v229, v252, s[36:39], s47 offen offset:1280 sc1
    buffer_load_dword v230, v252, s[36:39], s47 offen offset:2560 sc1
    s_add_u32 s47, s47, 3840
    buffer_load_dword v231, v252, s[36:39], s47 offen offset:0 sc1
    buffer_load_dword v232, v252, s[36:39], s47 offen offset:1280 sc1
    buffer_load_dword v233, v252, s[36:39], s47 offen offset:2560 sc1
    s_add_u32 s47, s47, 3840
    buffer_load_dword v234, v252, s[36:39], s47 offen offset:0 sc1
    buffer_load_dword v235, v252, s[36:39], s47 offen offset:1280 sc1
    s_waitcnt vmcnt(0)
    s_cmp_ge_u32 s42, 5
    s_cbranch_scc1 K1_NOREDM
    v_add_f32 v228, v228, v232
    v_add_f32 v229, v229, v233
    v_add_f32 v230, v230, v234
    v_add_f32 v231, v231, v235
    v_add_f32 v228, v228, v229
    v_add_f32 v230, v230, v231
    s_lshl_b32 s57, s42, 8
    s_add_u32 s57, s57, 79872
    v_add_f32 v228, v228, v230
    v_lshl_add_u32 v246, v255, 2, s57
    ds_write_b32 v246, v228
K1_NOREDM:
    s_waitcnt lgkmcnt(0)
    s_barrier
    s_branch K1_EPI2
K1_SLOW2:
    v_lshlrev_b32 v228, 4, v255
    v_lshrrev_b32 v229, 5, v255
    v_lshlrev_b32 v229, 30, v229
    v_lshl_add_u32 v229, v255, 2, v229
    v_add_u32 v229, 1024, v229
    s_mov_b32 s50, 0
    s_mov_b32 s63, s45
    s_lshl_b32 s58, s42, 9
K1_SROW:
    buffer_load_dwordx4 v[160:163], v228, s[20:23], s63 offen
    buffer_load_dword v164, v229, s[20:23], s63 offen
    s_waitcnt vmcnt(0)
    v_and_b32 v165, s56, v160
    v_lshlrev_b32 v166, 16, v160
    v_and_b32 v167, s56, v161
    v_lshlrev_b32 v168, 16, v161
    v_and_b32 v169, s56, v162
    v_lshlrev_b32 v170, 16, v162
    v_and_b32 v171, s56, v163
    v_lshlrev_b32 v172, 16, v163
    v_and_b32 v173, s56, v164
    v_lshlrev_b32 v174, 16, v164
    v_add_f32 v175, v165, v166
    v_add_f32 v175, v175, v167
    v_add_f32 v175, v175, v168
    v_add_f32 v175, v175, v169
    v_add_f32 v175, v175, v170
    v_add_f32 v175, v175, v171
    v_add_f32 v175, v175, v172
    v_add_f32 v175, v175, v173
    v_add_f32 v175, v175, v174
    s_nop 1
    v_add_f32_dpp v175, v175, v175 row_shr:1 row_mask:0xf bank_mask:0xf bound_ctrl:0
    s_nop 1
    v_add_f32_dpp v175, v175, v175 row_shr:2 row_mask:0xf bank_mask:0xf bound_ctrl:0
    s_nop 1
    v_add_f32_dpp v175, v175, v175 row_shr:4 row_mask:0xf bank_mask:0xf bound_ctrl:0
    s_nop 1
    v_add_f32_dpp v175, v175, v175 row_shr:8 row_mask:0xf bank_mask:0xf bound_ctrl:0
    s_nop 1
    v_add_f32_dpp v175, v175, v175 row_bcast:15 row_mask:0xa bank_mask:0xf bound_ctrl:0
    s_nop 1
    v_add_f32_dpp v175, v175, v175 row_bcast:31 row_mask:0xc bank_mask:0xf bound_ctrl:0
    v_mul_f32 v175, 0x3ae38e39, v175
    s_nop 0
    v_readlane_b32 s57, v175, 63
    s_nop 1
    v_subrev_f32 v165, s57, v165
    v_subrev_f32 v166, s57, v166
    v_subrev_f32 v167, s57, v167
    v_subrev_f32 v168, s57, v168
    v_subrev_f32 v169, s57, v169
    v_subrev_f32 v170, s57, v170
    v_subrev_f32 v171, s57, v171
    v_subrev_f32 v172, s57, v172
    s_mov_b32 exec_hi, 0
    v_subrev_f32 v173, s57, v173
    v_subrev_f32 v174, s57, v174
    s_mov_b64 exec, -1
    v_mul_f32 v160, v165, v165
    v_fmac_f32 v160, v166, v166
    v_fmac_f32 v160, v167, v167
    v_fmac_f32 v160, v168, v168
    v_fmac_f32 v160, v169, v169
    v_fmac_f32 v160, v170, v170
    v_fmac_f32 v160, v171, v171
    v_fmac_f32 v160, v172, v172
    v_fmac_f32 v160, v173, v173
    v_fmac_f32 v160, v174, v174
    s_nop 1
    v_add_f32_dpp v160, v160, v160 row_shr:1 row_mask:0xf bank_mask:0xf bound_ctrl:0
    s_nop 1
    v_add_f32_dpp v160, v160, v160 row_shr:2 row_mask:0xf bank_mask:0xf bound_ctrl:0
    s_nop 1
    v_add_f32_dpp v160, v160, v160 row_shr:4 row_mask:0xf bank_mask:0xf bound_ctrl:0
    s_nop 1
    v_add_f32_dpp v160, v160, v160 row_shr:8 row_mask:0xf bank_mask:0xf bound_ctrl:0
    s_nop 1
    v_add_f32_dpp v160, v160, v160 row_bcast:15 row_mask:0xa bank_mask:0xf bound_ctrl:0
    s_nop 1
    v_add_f32_dpp v160, v160, v160 row_bcast:31 row_mask:0xc bank_mask:0xf bound_ctrl:0
    v_mul_f32 v160, 0x3ae38e39, v160
    v_cvt_pk_bf16_f32 v232, v175, v175
    v_and_b32 v232, s56, v232
    v_xor_b32 v232, 0x80000000, v232
    v_cvt_pk_bf16_f32 v160, v160, v160
    v_and_b32 v160, s56, v160
    v_add_f32 v160, 0x3727c5ac, v160
    v_cvt_pk_bf16_f32 v160, v160, v160
    v_and_b32 v160, s56, v160
    v_sqrt_f32 v160, v160
    s_nop 0
    v_cvt_pk_bf16_f32 v160, v160, v160
    v_and_b32 v160, s56, v160
    v_rcp_f32 v235, v160
    v_mul_f32 v234, v160, v160
    v_mul_f32 v233, 0xbfb8aa3b, v235
    v_mov_b32 v246, s58
    s_mov_b32 exec_lo, 0
    s_mov_b32 exec_hi, 0x80000000
    ds_write_b128 v246, v[232:235] offset:0
    s_mov_b64 exec, -1
    s_waitcnt lgkmcnt(0)
    s_add_u32 s58, s58, 16
    s_add_u32 s63, s63, 1152
    s_add_u32 s50, s50, 1
    s_cmp_lt_u32 s50, 32
    s_cbranch_scc1 K1_SROW
    s_load_dwordx8 s[4:11], s[0:1], 0
    s_waitcnt lgkmcnt(0)
    s_mov_b32 s12, s6
    s_and_b32 s13, s7, 0xffff
    s_mov_b32 s14, 0xa2000
    s_mov_b32 s15, 0x00020000
    s_cmp_lt_u32 s40, 3
    s_cselect_b32 s32, s8, s10
    s_cselect_b32 s33, s9, s11
    s_cselect_b32 s58, 0, 3
    s_and_b32 s33, s33, 0xffff
    s_mov_b32 s34, 0x5100
    s_mov_b32 s35, 0x00020000
    s_sub_u32 s58, s40, s58
    s_min_u32 s58, s58, 2
    s_mul_i32 s58, s58, 12
    s_lshl_b32 s57, s42, 6
    v_add_u32 v160, s57, v255
    v_mov_b32 v165, 0x40000000
    v_lshrrev_b32 v246, 5, v160
    v_and_b32 v247, 15, v160
    v_lshl_add_u32 v246, v246, 4, v247
    v_lshl_add_u32 v246, v246, 1, s61
    v_cmp_gt_u32 vcc, 288, v160
    v_and_b32 v248, 16, v160
    s_nop 0
    v_cndmask_b32 v246, v165, v246, vcc
    v_cmp_eq_u32 vcc, 0, v248
    s_nop 1
    v_cndmask_b32 v161, v165, v246, vcc
    v_cndmask_b32 v162, v246, v165, vcc
    v_subrev_u32 v246, 288, v160
    s_mul_i32 s57, s40, 36
    v_lshl_add_u32 v247, v246, 1, s57
    v_cmp_gt_u32 vcc, 20, v246
    s_nop 1
    v_cndmask_b32 v163, v165, v247, vcc
    v_subrev_u32 v246, 308, v160
    v_lshl_add_u32 v247, v246, 1, s58
    v_cmp_gt_u32 vcc, 12, v246
    s_nop 1
    v_cndmask_b32 v164, v165, v247, vcc
    v_mov_b32 v166, 0
    s_mov_b32 s50, 0
K1_SCOL:
    s_add_u32 s57, s50, 0
    s_mul_i32 s58, s57, 9216
    buffer_load_ushort v168, v161, s[24:27], s58 offen
    buffer_load_ushort v169, v162, s[28:31], s58 offen
    s_mul_i32 s58, s57, 1152
    buffer_load_ushort v170, v163, s[12:15], s58 offen
    s_mul_i32 s58, s57, 36
    buffer_load_ushort v171, v164, s[32:35], s58 offen
    s_add_u32 s57, s50, 1
    s_mul_i32 s58, s57, 9216
    buffer_load_ushort v172, v161, s[24:27], s58 offen
    buffer_load_ushort v173, v162, s[28:31], s58 offen
    s_mul_i32 s58, s57, 1152
    buffer_load_ushort v174, v163, s[12:15], s58 offen
    s_mul_i32 s58, s57, 36
    buffer_load_ushort v175, v164, s[32:35], s58 offen
    s_add_u32 s57, s50, 2
    s_mul_i32 s58, s57, 9216
    buffer_load_ushort v176, v161, s[24:27], s58 offen
    buffer_load_ushort v177, v162, s[28:31], s58 offen
    s_mul_i32 s58, s57, 1152
    buffer_load_ushort v178, v163, s[12:15], s58 offen
    s_mul_i32 s58, s57, 36
    buffer_load_ushort v179, v164, s[32:35], s58 offen
    s_add_u32 s57, s50, 3
    s_mul_i32 s58, s57, 9216
    buffer_load_ushort v180, v161, s[24:27], s58 offen
    buffer_load_ushort v181, v162, s[28:31], s58 offen
    s_mul_i32 s58, s57, 1152
    buffer_load_ushort v182, v163, s[12:15], s58 offen
    s_mul_i32 s58, s57, 36
    buffer_load_ushort v183, v164, s[32:35], s58 offen
    s_waitcnt vmcnt(0)
    v_lshlrev_b32 v168, 16, v168
    v_add_f32 v166, v166, v168
    v_lshlrev_b32 v169, 16, v169
    v_add_f32 v166, v166, v169
    v_lshlrev_b32 v170, 16, v170
    v_add_f32 v166, v166, v170
    v_lshlrev_b32 v171, 16, v171
    v_add_f32 v166, v166, v171
    v_lshlrev_b32 v172, 16, v172
    v_add_f32 v166, v166, v172
    v_lshlrev_b32 v173, 16, v173
    v_add_f32 v166, v166, v173
    v_lshlrev_b32 v174, 16, v174
    v_add_f32 v166, v166, v174
    v_lshlrev_b32 v175, 16, v175
    v_add_f32 v166, v166, v175
    v_lshlrev_b32 v176, 16, v176
    v_add_f32 v166, v166, v176
    v_lshlrev_b32 v177, 16, v177
    v_add_f32 v166, v166, v177
    v_lshlrev_b32 v178, 16, v178
    v_add_f32 v166, v166, v178
    v_lshlrev_b32 v179, 16, v179
    v_add_f32 v166, v166, v179
    v_lshlrev_b32 v180, 16, v180
    v_add_f32 v166, v166, v180
    v_lshlrev_b32 v181, 16, v181
    v_add_f32 v166, v166, v181
    v_lshlrev_b32 v182, 16, v182
    v_add_f32 v166, v166, v182
    v_lshlrev_b32 v183, 16, v183
    v_add_f32 v166, v166, v183
    s_add_u32 s50, s50, 4
    s_cmp_lt_u32 s50, 576
    s_cbranch_scc1 K1_SCOL
    s_cmp_ge_u32 s42, 5
    s_cbranch_scc1 K1_SC2
    v_lshlrev_b32 v246, 2, v160
    v_add_u32 v246, 79872, v246
    ds_write_b32 v246, v166
K1_SC2:
    s_waitcnt lgkmcnt(0)
    s_barrier
    v_and_b32 v246, 15, v255
    s_lshl_b32 s57, s43, 10
    v_lshl_add_u32 v246, v246, 4, s57
    ds_read_b128 v[212:215], v246 offset:0
    ds_read_b128 v[216:219], v246 offset:256
    ds_read_b128 v[220:223], v246 offset:512
    ds_read_b128 v[224:227], v246 offset:768
    s_waitcnt lgkmcnt(0)
    s_branch K1_EPI2
.globl k2_kernel
.p2align 8
.type k2_kernel,@function
k2_kernel:
    s_cmp_ge_u32 s2, 512
    s_cbranch_scc1 K2_EXIT
    s_and_b32 s3, s2, 255
    s_cmp_ge_u32 s2, 256
    s_cbranch_scc1 K2_GEMM
    s_load_dwordx2 s[16:17], s[0:1], 88
    v_and_b32 v135, 63, v0
    v_lshrrev_b32 v136, 6, v0
    v_lshlrev_b32 v134, 4, v135
    v_readfirstlane_b32 s40, v136
    v_and_b32 v137, 31, v135
    v_lshlrev_b32 v132, 2, v137
    s_lshl_b32 s41, s3, 3
    s_lshl_b32 s43, s40, 1
    s_add_u32 s41, s41, s43
    s_mul_i32 s49, s40, 5120
    s_mov_b32 s48, s49
    s_mov_b32 s45, 0
    s_mov_b32 s46, 20480
    s_mov_b32 s47, 40960
    s_mov_b32 s56, 61440
    s_waitcnt lgkmcnt(0)
    s_mov_b32 s24, s16
    s_and_b32 s25, s17, 0xffff
    s_mov_b32 s26, 0x10000000
    s_mov_b32 s27, 0x00020000
    s_add_u32 s18, s16, 21233664
    s_addc_u32 s19, s17, 0
    s_mov_b32 s20, s18
    s_and_b32 s21, s19, 0xffff
    s_mov_b32 s22, 0x28000
    s_mov_b32 s23, 0x00020000
    s_add_u32 m0, s45, s49
    s_nop 0
    buffer_load_dwordx4 v134, s[20:23], s48 offen lds
    buffer_load_dwordx4 v134, s[20:23], s48 offen offset:1024 lds
    buffer_load_dwordx4 v134, s[20:23], s48 offen offset:2048 lds
    buffer_load_dwordx4 v134, s[20:23], s48 offen offset:3072 lds
    s_add_u32 m0, m0, 4096
    s_add_u32 s43, s48, 4096
    buffer_load_dwordx4 v134, s[20:23], s43 offen lds
    s_add_u32 s48, s48, 20480
    s_lshl_b32 s43, s41, 10
    s_add_u32 s43, s43, 18874368
    s_lshl_b32 s44, s41, 7
    s_add_u32 s44, s44, 20971520
    buffer_load_dwordx4 v[80:83], v134, s[24:27], s43 offen offset:0
    buffer_load_dword v88, v132, s[24:27], s44 offen offset:0
    buffer_load_dwordx4 v[84:87], v134, s[24:27], s43 offen offset:1024
    buffer_load_dword v92, v132, s[24:27], s44 offen offset:128
    s_add_u32 m0, s46, s49
    s_nop 0
    buffer_load_dwordx4 v134, s[20:23], s48 offen lds
    buffer_load_dwordx4 v134, s[20:23], s48 offen offset:1024 lds
    buffer_load_dwordx4 v134, s[20:23], s48 offen offset:2048 lds
    buffer_load_dwordx4 v134, s[20:23], s48 offen offset:3072 lds
    s_add_u32 m0, m0, 4096
    s_add_u32 s43, s48, 4096
    buffer_load_dwordx4 v134, s[20:23], s43 offen lds
    s_add_u32 s48, s48, 20480
    s_add_u32 m0, s47, s49
    s_nop 0
    buffer_load_dwordx4 v134, s[20:23], s48 offen lds
    buffer_load_dwordx4 v134, s[20:23], s48 offen offset:1024 lds
    buffer_load_dwordx4 v134, s[20:23], s48 offen offset:2048 lds
    buffer_load_dwordx4 v134, s[20:23], s48 offen offset:3072 lds
    s_add_u32 m0, m0, 4096
    s_add_u32 s43, s48, 4096
    buffer_load_dwordx4 v134, s[20:23], s43 offen lds
    s_add_u32 s48, s48, 20480
    s_add_u32 m0, s56, s49
    s_nop 0
    buffer_load_dwordx4 v134, s[20:23], s48 offen lds
    buffer_load_dwordx4 v134, s[20:23], s48 offen offset:1024 lds
    buffer_load_dwordx4 v134, s[20:23], s48 offen offset:2048 lds
    buffer_load_dwordx4 v134, s[20:23], s48 offen offset:3072 lds
    s_add_u32 m0, m0, 4096
    s_add_u32 s43, s48, 4096
    buffer_load_dwordx4 v134, s[20:23], s43 offen lds
    s_add_u32 s48, s48, 20480
    v_mov_b32 v131, v134
    v_lshrrev_b32 v138, 5, v135
    v_mul_u32_u24 v138, 18, v138
    v_add_u32 v138, v138, v137
    v_mov_b32 v139, 36
    v_cmp_gt_u32 vcc, 18, v137
    s_nop 1
    v_cndmask_b32 v138, v139, v138, vcc
    v_and_b32 v139, 27, v137
    v_cmp_eq_u32 vcc, 18, v139
    v_cmp_gt_u32 s[52:53], 18, v137
    s_or_b64 vcc, vcc, s[52:53]
    v_mov_b32 v139, 37
    s_nop 1
    v_cndmask_b32 v138, v139, v138, vcc
    v_lshlrev_b32 v133, 4, v138
    v_mov_b32 v128, v131
    v_mov_b32 v129, v132
    v_mov_b32 v130, v133
    v_mov_b32 v105, 0x3f80
    v_mov_b64 v[106:107], 0
    v_mov_b32 v89, 0
    v_mov_b64 v[90:91], 0
    v_mov_b64 v[32:33], 0
    v_mov_b64 v[34:35], 0
    v_mov_b64 v[36:37], 0
    v_mov_b64 v[38:39], 0
    v_mov_b64 v[40:41], 0
    v_mov_b64 v[42:43], 0
    v_mov_b64 v[44:45], 0
    v_mov_b64 v[46:47], 0
    v_mov_b32 v109, 0x3f80
    v_mov_b64 v[110:111], 0
    v_mov_b32 v93, 0
    v_mov_b64 v[94:95], 0
    v_mov_b64 v[48:49], 0
    v_mov_b64 v[50:51], 0
    v_mov_b64 v[52:53], 0
    v_mov_b64 v[54:55], 0
    v_mov_b64 v[56:57], 0
    v_mov_b64 v[58:59], 0
    v_mov_b64 v[60:61], 0
    v_mov_b64 v[62:63], 0
    v_mov_b64 v[72:73], 0
    v_mov_b64 v[120:121], 0
    v_mov_b64 v[74:75], 0
    v_mov_b64 v[122:123], 0
    v_mov_b64 v[76:77], 0
    v_mov_b64 v[124:125], 0
    v_mov_b64 v[78:79], 0
    v_mov_b64 v[126:127], 0
    s_waitcnt vmcnt(15)
    s_barrier
    ds_read_b128 v[96:99], v128 offset:0
    ds_read_b32 v104, v129 offset:18432
    ds_read_b128 v[112:115], v130 offset:8192
    ds_read_b128 v[116:119], v130 offset:8832
    s_mov_b32 exec_lo, 0
    v_mov_b32 v88, 0
    v_mov_b32 v92, 0
    s_mov_b64 exec, -1
    s_waitcnt lgkmcnt(0)
    v_mfma_f32_32x32x16_bf16 v[0:15], v[96:99], v[80:83], 0
    v_mfma_f32_32x32x16_bf16 v[0:15], v[104:107], v[88:91], v[0:15]
    v_mfma_f32_32x32x16_bf16 v[16:31], v[96:99], v[84:87], 0
    v_mfma_f32_32x32x16_bf16 v[16:31], v[104:107], v[92:95], v[16:31]
    s_nop 15
    v_max3_f32 v136, v0, v1, v2
    v_max3_f32 v136, v136, v3, v4
    v_max3_f32 v136, v136, v5, v6
    v_max3_f32 v136, v136, v7, v8
    v_max3_f32 v136, v136, v9, v10
    v_max3_f32 v136, v136, v11, v12
    v_max3_f32 v136, v136, v13, v14
    v_max_f32 v136, v136, v15
    v_mov_b32 v137, v136
    s_nop 1
    v_permlane32_swap_b32 v136, v137
    s_nop 1
    v_max_f32 v136, v136, v137
    v_sub_f32 v136, 0, v136
    v_mov_b32 v137, 0
    s_mov_b32 exec_hi, 0
    v_cvt_pk_bf16_f32 v89, v136, v137
    s_mov_b64 exec, -1
    v_max3_f32 v138, v16, v17, v18
    v_max3_f32 v138, v138, v19, v20
    v_max3_f32 v138, v138, v21, v22
    v_max3_f32 v138, v138, v23, v24
    v_max3_f32 v138, v138, v25, v26
    v_max3_f32 v138, v138, v27, v28
    v_max3_f32 v138, v138, v29, v30
    v_max_f32 v138, v138, v31
    v_mov_b32 v139, v138
    s_nop 1
    v_permlane32_swap_b32 v138, v139
    s_nop 1
    v_max_f32 v138, v138, v139
    v_sub_f32 v138, 0, v138
    v_mov_b32 v139, 0
    s_mov_b32 exec_hi, 0
    v_cvt_pk_bf16_f32 v93, v138, v139
    s_mov_b64 exec, -1
    s_nop 4
    v_mfma_f32_32x32x16_bf16 v[0:15], v[96:99], v[80:83], 0
    v_mfma_f32_32x32x16_bf16 v[0:15], v[104:107], v[88:91], v[0:15]
    s_mov_b32 s42, 0
    s_nop 15
.p2align 6
K2A_LOOP:
    s_cmp_lt_u32 s42, 6
    s_cbranch_scc1 K2A_W5
    s_waitcnt vmcnt(0)
K2A_W5:
    s_waitcnt vmcnt(5)
    s_barrier
    s_sub_u32 s43, s42, 1
    s_cmp_lt_u32 s43, 4
    s_cselect_b64 vcc, -1, 0
    v_mfma_f32_32x32x16_bf16 v[16:31], v[96:99], v[84:87], 0
    ds_read_b128 v[100:103], v128 offset:1024
    v_exp_f32 v0, v0
    v_exp_f32 v1, v1
    v_exp_f32 v2, v2
    v_cvt_pk_bf16_f32 v64, v0, v1
    v_exp_f32 v3, v3
    v_exp_f32 v4, v4
    v_mfma_f32_32x32x16_bf16 v[16:31], v[104:107], v[92:95], v[16:31]
    ds_read_b32 v108, v129 offset:18560
    v_cvt_pk_bf16_f32 v65, v2, v3
    v_exp_f32 v5, v5
    v_exp_f32 v6, v6
    v_cvt_pk_bf16_f32 v66, v4, v5
    v_exp_f32 v7, v7
    v_exp_f32 v8, v8
    v_mfma_f32_32x32x16_bf16 v[48:63], v[120:123], v[72:75], v[48:63]
    v_cvt_pk_bf16_f32 v67, v6, v7
    v_exp_f32 v9, v9
    v_exp_f32 v10, v10
    v_cvt_pk_bf16_f32 v68, v8, v9
    v_exp_f32 v11, v11
    v_exp_f32 v12, v12
    v_mfma_f32_32x32x16_bf16 v[48:63], v[124:127], v[76:79], v[48:63]
    v_cvt_pk_bf16_f32 v69, v10, v11
    v_exp_f32 v13, v13
    v_exp_f32 v14, v14
    v_exp_f32 v15, v15
    v_cvt_pk_bf16_f32 v70, v12, v13
    v_cvt_pk_bf16_f32 v71, v14, v15
    s_waitcnt lgkmcnt(0)
    v_mfma_f32_32x32x16_bf16 v[0:15], v[100:103], v[80:83], 0
    ds_read_b128 v[120:123], v130 offset:9472
    v_exp_f32 v16, v16
    v_exp_f32 v17, v17
    v_exp_f32 v18, v18
    v_cvt_pk_bf16_f32 v72, v16, v17
    v_exp_f32 v19, v19
    v_exp_f32 v20, v20
    v_mfma_f32_32x32x16_bf16 v[0:15], v[108:111], v[88:91], v[0:15]
    ds_read_b128 v[124:127], v130 offset:10112
    v_cvt_pk_bf16_f32 v73, v18, v19
    v_exp_f32 v21, v21
    v_exp_f32 v22, v22
    v_cvt_pk_bf16_f32 v74, v20, v21
    v_exp_f32 v23, v23
    v_exp_f32 v24, v24
    v_mfma_f32_32x32x16_bf16 v[32:47], v[112:115], v[64:67], v[32:47]
    v_cvt_pk_bf16_f32 v75, v22, v23
    v_exp_f32 v25, v25
    v_exp_f32 v26, v26
    v_cvt_pk_bf16_f32 v76, v24, v25
    v_exp_f32 v27, v27
    v_exp_f32 v28, v28
    v_mfma_f32_32x32x16_bf16 v[32:47], v[116:119], v[68:71], v[32:47]
    v_cvt_pk_bf16_f32 v77, v26, v27
    v_exp_f32 v29, v29
    v_exp_f32 v30, v30
    v_exp_f32 v31, v31
    v_cvt_pk_bf16_f32 v78, v28, v29
    v_cvt_pk_bf16_f32 v79, v30, v31
    v_mfma_f32_32x32x16_bf16 v[16:31], v[100:103], v[84:87], 0
    ds_read_b128 v[96:99], v128 offset:2048
    v_exp_f32 v0, v0
    v_exp_f32 v1, v1
    v_exp_f32 v2, v2
    v_cvt_pk_bf16_f32 v64, v0, v1
    v_exp_f32 v3, v3
    v_exp_f32 v4, v4
    v_mfma_f32_32x32x16_bf16 v[16:31], v[108:111], v[92:95], v[16:31]
    ds_read_b32 v104, v129 offset:18688
    v_cvt_pk_bf16_f32 v65, v2, v3
    v_exp_f32 v5, v5
    v_exp_f32 v6, v6
    v_cvt_pk_bf16_f32 v66, v4, v5
    v_exp_f32 v7, v7
    v_exp_f32 v8, v8
    v_mfma_f32_32x32x16_bf16 v[48:63], v[112:115], v[72:75], v[48:63]
    v_cvt_pk_bf16_f32 v67, v6, v7
    v_exp_f32 v9, v9
    v_exp_f32 v10, v10
    v_cvt_pk_bf16_f32 v68, v8, v9
    v_exp_f32 v11, v11
    v_exp_f32 v12, v12
    v_mfma_f32_32x32x16_bf16 v[48:63], v[116:119], v[76:79], v[48:63]
    v_cvt_pk_bf16_f32 v69, v10, v11
    v_exp_f32 v13, v13
    v_exp_f32 v14, v14
    v_exp_f32 v15, v15
    v_cvt_pk_bf16_f32 v70, v12, v13
    v_cvt_pk_bf16_f32 v71, v14, v15
    s_waitcnt lgkmcnt(0)
    v_mfma_f32_32x32x16_bf16 v[0:15], v[96:99], v[80:83], 0
    ds_read_b128 v[112:115], v130 offset:10752
    v_exp_f32 v16, v16
    v_exp_f32 v17, v17
    v_exp_f32 v18, v18
    v_cvt_pk_bf16_f32 v72, v16, v17
    v_exp_f32 v19, v19
    v_exp_f32 v20, v20
    v_mfma_f32_32x32x16_bf16 v[0:15], v[104:107], v[88:91], v[0:15]
    ds_read_b128 v[116:119], v130 offset:11392
    v_cvt_pk_bf16_f32 v73, v18, v19
    v_exp_f32 v21, v21
    v_exp_f32 v22, v22
    v_cvt_pk_bf16_f32 v74, v20, v21
    v_exp_f32 v23, v23
    v_exp_f32 v24, v24
    v_mfma_f32_32x32x16_bf16 v[32:47], v[120:123], v[64:67], v[32:47]
    v_cvt_pk_bf16_f32 v75, v22, v23
    v_exp_f32 v25, v25
    v_exp_f32 v26, v26
    v_cvt_pk_bf16_f32 v76, v24, v25
    v_exp_f32 v27, v27
    v_exp_f32 v28, v28
    v_mfma_f32_32x32x16_bf16 v[32:47], v[124:127], v[68:71], v[32:47]
    v_cvt_pk_bf16_f32 v77, v26, v27
    v_exp_f32 v29, v29
    v_exp_f32 v30, v30
    v_exp_f32 v31, v31
    v_cvt_pk_bf16_f32 v78, v28, v29
    v_cvt_pk_bf16_f32 v79, v30, v31
    v_mfma_f32_32x32x16_bf16 v[16:31], v[96:99], v[84:87], 0
    ds_read_b128 v[100:103], v128 offset:3072
    v_exp_f32 v0, v0
    v_exp_f32 v1, v1
    v_exp_f32 v2, v2
    v_cvt_pk_bf16_f32 v64, v0, v1
    v_exp_f32 v3, v3
    v_exp_f32 v4, v4
    v_mfma_f32_32x32x16_bf16 v[16:31], v[104:107], v[92:95], v[16:31]
    ds_read_b32 v108, v129 offset:18816
    v_cvt_pk_bf16_f32 v65, v2, v3
    v_exp_f32 v5, v5
    v_exp_f32 v6, v6
    v_cvt_pk_bf16_f32 v66, v4, v5
    v_exp_f32 v7, v7
    v_exp_f32 v8, v8
    v_mfma_f32_32x32x16_bf16 v[48:63], v[120:123], v[72:75], v[48:63]
    v_cvt_pk_bf16_f32 v67, v6, v7
    v_exp_f32 v9, v9
    v_exp_f32 v10, v10
    v_cvt_pk_bf16_f32 v68, v8, v9
    v_exp_f32 v11, v11
    v_exp_f32 v12, v12
    v_mfma_f32_32x32x16_bf16 v[48:63], v[124:127], v[76:79], v[48:63]
    v_cvt_pk_bf16_f32 v69, v10, v11
    v_exp_f32 v13, v13
    v_exp_f32 v14, v14
    v_exp_f32 v15, v15
    v_cvt_pk_bf16_f32 v70, v12, v13
    v_cvt_pk_bf16_f32 v71, v14, v15
    s_waitcnt lgkmcnt(0)
    v_mfma_f32_32x32x16_bf16 v[0:15], v[100:103], v[80:83], 0
    ds_read_b128 v[120:123], v130 offset:12032
    v_exp_f32 v16, v16
    v_exp_f32 v17, v17
    v_exp_f32 v18, v18
    v_cvt_pk_bf16_f32 v72, v16, v17
    v_exp_f32 v19, v19
    v_exp_f32 v20, v20
    v_mfma_f32_32x32x16_bf16 v[0:15], v[108:111], v[88:91], v[0:15]
    ds_read_b128 v[124:127], v130 offset:12672
    v_cvt_pk_bf16_f32 v73, v18, v19
    v_exp_f32 v21, v21
    v_exp_f32 v22, v22
    v_cvt_pk_bf16_f32 v74, v20, v21
    v_exp_f32 v23, v23
    v_exp_f32 v24, v24
    v_mfma_f32_32x32x16_bf16 v[32:47], v[112:115], v[64:67], v[32:47]
    v_cvt_pk_bf16_f32 v75, v22, v23
    v_exp_f32 v25, v25
    v_exp_f32 v26, v26
    v_cvt_pk_bf16_f32 v76, v24, v25
    v_exp_f32 v27, v27
    v_exp_f32 v28, v28
    v_mfma_f32_32x32x16_bf16 v[32:47], v[116:119], v[68:71], v[32:47]
    v_cvt_pk_bf16_f32 v77, v26, v27
    v_exp_f32 v29, v29
    v_exp_f32 v30, v30
    v_exp_f32 v31, v31
    v_cvt_pk_bf16_f32 v78, v28, v29
    v_cvt_pk_bf16_f32 v79, v30, v31
    v_mfma_f32_32x32x16_bf16 v[16:31], v[100:103], v[84:87], 0
    ds_read_b128 v[96:99], v128 offset:4096
    v_exp_f32 v0, v0
    v_exp_f32 v1, v1
    v_exp_f32 v2, v2
    v_cvt_pk_bf16_f32 v64, v0, v1
    v_exp_f32 v3, v3
    v_exp_f32 v4, v4
    v_mfma_f32_32x32x16_bf16 v[16:31], v[108:111], v[92:95], v[16:31]
    ds_read_b32 v104, v129 offset:18944
    v_cvt_pk_bf16_f32 v65, v2, v3
    v_exp_f32 v5, v5
    v_exp_f32 v6, v6
    v_cvt_pk_bf16_f32 v66, v4, v5
    v_exp_f32 v7, v7
    v_exp_f32 v8, v8
    v_mfma_f32_32x32x16_bf16 v[48:63], v[112:115], v[72:75], v[48:63]
    s_cbranch_vccz K2A_ND3
    s_add_u32 m0, s56, s49
    s_nop 0
    buffer_load_dwordx4 v134, s[20:23], s48 offen lds
    K2A_ND3:
    v_cvt_pk_bf16_f32 v67, v6, v7
    v_exp_f32 v9, v9
    v_exp_f32 v10, v10
    v_cvt_pk_bf16_f32 v68, v8, v9
    v_exp_f32 v11, v11
    v_exp_f32 v12, v12
    v_mfma_f32_32x32x16_bf16 v[48:63], v[116:119], v[76:79], v[48:63]
    v_cvt_pk_bf16_f32 v69, v10, v11
    v_exp_f32 v13, v13
    v_exp_f32 v14, v14
    v_exp_f32 v15, v15
    v_cvt_pk_bf16_f32 v70, v12, v13
    v_cvt_pk_bf16_f32 v71, v14, v15
    s_waitcnt lgkmcnt(0)
    v_mfma_f32_32x32x16_bf16 v[0:15], v[96:99], v[80:83], 0
    ds_read_b128 v[112:115], v130 offset:13312
    v_exp_f32 v16, v16
    v_exp_f32 v17, v17
    v_exp_f32 v18, v18
    v_cvt_pk_bf16_f32 v72, v16, v17
    v_exp_f32 v19, v19
    v_exp_f32 v20, v20
    v_mfma_f32_32x32x16_bf16 v[0:15], v[104:107], v[88:91], v[0:15]
    ds_read_b128 v[116:119], v130 offset:13952
    v_cvt_pk_bf16_f32 v73, v18, v19
    v_exp_f32 v21, v21
    v_exp_f32 v22, v22
    v_cvt_pk_bf16_f32 v74, v20, v21
    v_exp_f32 v23, v23
    v_exp_f32 v24, v24
    v_mfma_f32_32x32x16_bf16 v[32:47], v[120:123], v[64:67], v[32:47]
    v_cvt_pk_bf16_f32 v75, v22, v23
    v_exp_f32 v25, v25
    v_exp_f32 v26, v26
    v_cvt_pk_bf16_f32 v76, v24, v25
    v_exp_f32 v27, v27
    v_exp_f32 v28, v28
    v_mfma_f32_32x32x16_bf16 v[32:47], v[124:127], v[68:71], v[32:47]
    v_cvt_pk_bf16_f32 v77, v26, v27
    v_exp_f32 v29, v29
    v_exp_f32 v30, v30
    v_exp_f32 v31, v31
    v_cvt_pk_bf16_f32 v78, v28, v29
    v_cvt_pk_bf16_f32 v79, v30, v31
    v_mfma_f32_32x32x16_bf16 v[16:31], v[96:99], v[84:87], 0
    ds_read_b128 v[100:103], v128 offset:5120
    v_exp_f32 v0, v0
    v_exp_f32 v1, v1
    v_exp_f32 v2, v2
    v_cvt_pk_bf16_f32 v64, v0, v1
    v_exp_f32 v3, v3
    v_exp_f32 v4, v4
    v_mfma_f32_32x32x16_bf16 v[16:31], v[104:107], v[92:95], v[16:31]
    ds_read_b32 v108, v129 offset:19072
    v_cvt_pk_bf16_f32 v65, v2, v3
    v_exp_f32 v5, v5
    v_exp_f32 v6, v6
    v_cvt_pk_bf16_f32 v66, v4, v5
    v_exp_f32 v7, v7
    v_exp_f32 v8, v8
    v_mfma_f32_32x32x16_bf16 v[48:63], v[120:123], v[72:75], v[48:63]
    s_cbranch_vccz K2A_ND4
    buffer_load_dwordx4 v134, s[20:23], s48 offen offset:1024 lds
    K2A_ND4:
    v_cvt_pk_bf16_f32 v67, v6, v7
    v_exp_f32 v9, v9
    v_exp_f32 v10, v10
    v_cvt_pk_bf16_f32 v68, v8, v9
    v_exp_f32 v11, v11
    v_exp_f32 v12, v12
    v_mfma_f32_32x32x16_bf16 v[48:63], v[124:127], v[76:79], v[48:63]
    v_cvt_pk_bf16_f32 v69, v10, v11
    v_exp_f32 v13, v13
    v_exp_f32 v14, v14
    v_exp_f32 v15, v15
    v_cvt_pk_bf16_f32 v70, v12, v13
    v_cvt_pk_bf16_f32 v71, v14, v15
    s_waitcnt lgkmcnt(0)
    v_mfma_f32_32x32x16_bf16 v[0:15], v[100:103], v[80:83], 0
    ds_read_b128 v[120:123], v130 offset:14592
    v_exp_f32 v16, v16
    v_exp_f32 v17, v17
    v_exp_f32 v18, v18
    v_cvt_pk_bf16_f32 v72, v16, v17
    v_exp_f32 v19, v19
    v_exp_f32 v20, v20
    v_mfma_f32_32x32x16_bf16 v[0:15], v[108:111], v[88:91], v[0:15]
    ds_read_b128 v[124:127], v130 offset:15232
    v_cvt_pk_bf16_f32 v73, v18, v19
    v_exp_f32 v21, v21
    v_exp_f32 v22, v22
    v_cvt_pk_bf16_f32 v74, v20, v21
    v_exp_f32 v23, v23
    v_exp_f32 v24, v24
    v_mfma_f32_32x32x16_bf16 v[32:47], v[112:115], v[64:67], v[32:47]
    v_cvt_pk_bf16_f32 v75, v22, v23
    v_exp_f32 v25, v25
    v_exp_f32 v26, v26
    v_cvt_pk_bf16_f32 v76, v24, v25
    v_exp_f32 v27, v27
    v_exp_f32 v28, v28
    v_mfma_f32_32x32x16_bf16 v[32:47], v[116:119], v[68:71], v[32:47]
    v_cvt_pk_bf16_f32 v77, v26, v27
    v_exp_f32 v29, v29
    v_exp_f32 v30, v30
    v_exp_f32 v31, v31
    v_cvt_pk_bf16_f32 v78, v28, v29
    v_cvt_pk_bf16_f32 v79, v30, v31
    v_mfma_f32_32x32x16_bf16 v[16:31], v[100:103], v[84:87], 0
    ds_read_b128 v[96:99], v128 offset:6144
    v_exp_f32 v0, v0
    v_exp_f32 v1, v1
    v_exp_f32 v2, v2
    v_cvt_pk_bf16_f32 v64, v0, v1
    v_exp_f32 v3, v3
    v_exp_f32 v4, v4
    v_mfma_f32_32x32x16_bf16 v[16:31], v[108:111], v[92:95], v[16:31]
    ds_read_b32 v104, v129 offset:19200
    v_cvt_pk_bf16_f32 v65, v2, v3
    v_exp_f32 v5, v5
    v_exp_f32 v6, v6
    v_cvt_pk_bf16_f32 v66, v4, v5
    v_exp_f32 v7, v7
    v_exp_f32 v8, v8
    v_mfma_f32_32x32x16_bf16 v[48:63], v[112:115], v[72:75], v[48:63]
    s_cbranch_vccz K2A_ND5
    buffer_load_dwordx4 v134, s[20:23], s48 offen offset:2048 lds
    K2A_ND5:
    v_cvt_pk_bf16_f32 v67, v6, v7
    v_exp_f32 v9, v9
    v_exp_f32 v10, v10
    v_cvt_pk_bf16_f32 v68, v8, v9
    v_exp_f32 v11, v11
    v_exp_f32 v12, v12
    v_mfma_f32_32x32x16_bf16 v[48:63], v[116:119], v[76:79], v[48:63]
    v_cvt_pk_bf16_f32 v69, v10, v11
    v_exp_f32 v13, v13
    v_exp_f32 v14, v14
    v_exp_f32 v15, v15
    v_cvt_pk_bf16_f32 v70, v12, v13
    v_cvt_pk_bf16_f32 v71, v14, v15
    s_waitcnt lgkmcnt(0)
    v_mfma_f32_32x32x16_bf16 v[0:15], v[96:99], v[80:83], 0
    ds_read_b128 v[112:115], v130 offset:15872
    v_exp_f32 v16, v16
    v_exp_f32 v17, v17
    v_exp_f32 v18, v18
    v_cvt_pk_bf16_f32 v72, v16, v17
    v_exp_f32 v19, v19
    v_exp_f32 v20, v20
    v_mfma_f32_32x32x16_bf16 v[0:15], v[104:107], v[88:91], v[0:15]
    ds_read_b128 v[116:119], v130 offset:16512
    v_cvt_pk_bf16_f32 v73, v18, v19
    v_exp_f32 v21, v21
    v_exp_f32 v22, v22
    v_cvt_pk_bf16_f32 v74, v20, v21
    v_exp_f32 v23, v23
    v_exp_f32 v24, v24
    v_mfma_f32_32x32x16_bf16 v[32:47], v[120:123], v[64:67], v[32:47]
    v_cvt_pk_bf16_f32 v75, v22, v23
    v_exp_f32 v25, v25
    v_exp_f32 v26, v26
    v_cvt_pk_bf16_f32 v76, v24, v25
    v_exp_f32 v27, v27
    v_exp_f32 v28, v28
    v_mfma_f32_32x32x16_bf16 v[32:47], v[124:127], v[68:71], v[32:47]
    v_cvt_pk_bf16_f32 v77, v26, v27
    v_exp_f32 v29, v29
    v_exp_f32 v30, v30
    v_exp_f32 v31, v31
    v_cvt_pk_bf16_f32 v78, v28, v29
    v_cvt_pk_bf16_f32 v79, v30, v31
    v_mfma_f32_32x32x16_bf16 v[16:31], v[96:99], v[84:87], 0
    ds_read_b128 v[100:103], v128 offset:7168
    v_exp_f32 v0, v0
    v_exp_f32 v1, v1
    v_exp_f32 v2, v2
    v_cvt_pk_bf16_f32 v64, v0, v1
    v_exp_f32 v3, v3
    v_exp_f32 v4, v4
    v_mfma_f32_32x32x16_bf16 v[16:31], v[104:107], v[92:95], v[16:31]
    ds_read_b32 v108, v129 offset:19328
    v_cvt_pk_bf16_f32 v65, v2, v3
    v_exp_f32 v5, v5
    v_exp_f32 v6, v6
    v_cvt_pk_bf16_f32 v66, v4, v5
    v_exp_f32 v7, v7
    v_exp_f32 v8, v8
    v_mfma_f32_32x32x16_bf16 v[48:63], v[120:123], v[72:75], v[48:63]
    s_cbranch_vccz K2A_ND6
    buffer_load_dwordx4 v134, s[20:23], s48 offen offset:3072 lds
    K2A_ND6:
    v_cvt_pk_bf16_f32 v67, v6, v7
    v_exp_f32 v9, v9
    v_exp_f32 v10, v10
    v_cvt_pk_bf16_f32 v68, v8, v9
    v_exp_f32 v11, v11
    v_exp_f32 v12, v12
    v_mfma_f32_32x32x16_bf16 v[48:63], v[124:127], v[76:79], v[48:63]
    v_cvt_pk_bf16_f32 v69, v10, v11
    v_exp_f32 v13, v13
    v_exp_f32 v14, v14
    v_exp_f32 v15, v15
    v_cvt_pk_bf16_f32 v70, v12, v13
    v_cvt_pk_bf16_f32 v71, v14, v15
    s_waitcnt lgkmcnt(0)
    v_mfma_f32_32x32x16_bf16 v[0:15], v[100:103], v[80:83], 0
    ds_read_b128 v[120:123], v130 offset:17152
    v_exp_f32 v16, v16
    v_exp_f32 v17, v17
    v_exp_f32 v18, v18
    v_cvt_pk_bf16_f32 v72, v16, v17
    v_exp_f32 v19, v19
    v_exp_f32 v20, v20
    v_mfma_f32_32x32x16_bf16 v[0:15], v[108:111], v[88:91], v[0:15]
    ds_read_b128 v[124:127], v130 offset:17792
    v_cvt_pk_bf16_f32 v73, v18, v19
    v_exp_f32 v21, v21
    v_exp_f32 v22, v22
    v_cvt_pk_bf16_f32 v74, v20, v21
    v_exp_f32 v23, v23
    v_exp_f32 v24, v24
    v_mfma_f32_32x32x16_bf16 v[32:47], v[112:115], v[64:67], v[32:47]
    v_cvt_pk_bf16_f32 v75, v22, v23
    v_exp_f32 v25, v25
    v_exp_f32 v26, v26
    v_cvt_pk_bf16_f32 v76, v24, v25
    v_exp_f32 v27, v27
    v_exp_f32 v28, v28
    v_mfma_f32_32x32x16_bf16 v[32:47], v[116:119], v[68:71], v[32:47]
    v_cvt_pk_bf16_f32 v77, v26, v27
    v_exp_f32 v29, v29
    v_exp_f32 v30, v30
    v_exp_f32 v31, v31
    v_cvt_pk_bf16_f32 v78, v28, v29
    v_cvt_pk_bf16_f32 v79, v30, v31
    v_add_u32 v128, s46, v131
    v_add_u32 v129, s46, v132
    v_mfma_f32_32x32x16_bf16 v[16:31], v[100:103], v[84:87], 0
    ds_read_b128 v[96:99], v128 offset:0
    v_exp_f32 v0, v0
    v_exp_f32 v1, v1
    v_exp_f32 v2, v2
    v_cvt_pk_bf16_f32 v64, v0, v1
    v_exp_f32 v3, v3
    v_exp_f32 v4, v4
    v_mfma_f32_32x32x16_bf16 v[16:31], v[108:111], v[92:95], v[16:31]
    ds_read_b32 v104, v129 offset:18432
    v_cvt_pk_bf16_f32 v65, v2, v3
    v_exp_f32 v5, v5
    v_exp_f32 v6, v6
    v_cvt_pk_bf16_f32 v66, v4, v5
    v_exp_f32 v7, v7
    v_exp_f32 v8, v8
    v_mfma_f32_32x32x16_bf16 v[48:63], v[112:115], v[72:75], v[48:63]
    s_cbranch_vccz K2A_ND7
    s_add_u32 m0, m0, 4096
    s_add_u32 s43, s48, 4096
    buffer_load_dwordx4 v134, s[20:23], s43 offen lds
    s_add_u32 s48, s48, 20480
    K2A_ND7:
    v_cvt_pk_bf16_f32 v67, v6, v7
    v_exp_f32 v9, v9
    v_exp_f32 v10, v10
    v_cvt_pk_bf16_f32 v68, v8, v9
    v_exp_f32 v11, v11
    v_exp_f32 v12, v12
    v_mfma_f32_32x32x16_bf16 v[48:63], v[116:119], v[76:79], v[48:63]
    v_cvt_pk_bf16_f32 v69, v10, v11
    v_exp_f32 v13, v13
    v_exp_f32 v14, v14
    v_exp_f32 v15, v15
    v_cvt_pk_bf16_f32 v70, v12, v13
    v_cvt_pk_bf16_f32 v71, v14, v15
    v_add_u32 v130, s46, v133
    s_waitcnt lgkmcnt(0)
    v_mfma_f32_32x32x16_bf16 v[0:15], v[96:99], v[80:83], 0
    ds_read_b128 v[112:115], v130 offset:8192
    v_exp_f32 v16, v16
    v_exp_f32 v17, v17
    v_exp_f32 v18, v18
    v_cvt_pk_bf16_f32 v72, v16, v17
    v_exp_f32 v19, v19
    v_exp_f32 v20, v20
    v_mfma_f32_32x32x16_bf16 v[0:15], v[104:107], v[88:91], v[0:15]
    ds_read_b128 v[116:119], v130 offset:8832
    v_cvt_pk_bf16_f32 v73, v18, v19
    v_exp_f32 v21, v21
    v_exp_f32 v22, v22
    v_cvt_pk_bf16_f32 v74, v20, v21
    v_exp_f32 v23, v23
    v_exp_f32 v24, v24
    v_mfma_f32_32x32x16_bf16 v[32:47], v[120:123], v[64:67], v[32:47]
    v_cvt_pk_bf16_f32 v75, v22, v23
    v_exp_f32 v25, v25
    v_exp_f32 v26, v26
    v_cvt_pk_bf16_f32 v76, v24, v25
    v_exp_f32 v27, v27
    v_exp_f32 v28, v28
    v_mfma_f32_32x32x16_bf16 v[32:47], v[124:127], v[68:71], v[32:47]
    v_cvt_pk_bf16_f32 v77, v26, v27
    v_exp_f32 v29, v29
    v_exp_f32 v30, v30
    v_exp_f32 v31, v31
    v_cvt_pk_bf16_f32 v78, v28, v29
    v_cvt_pk_bf16_f32 v79, v30, v31
    s_mov_b32 s43, s45
    s_mov_b32 s45, s46
    s_mov_b32 s46, s47
    s_mov_b32 s47, s56
    s_mov_b32 s56, s43
    s_add_u32 s42, s42, 1
    s_cmp_lt_u32 s42, 8
    s_cbranch_scc1 K2A_LOOP
    v_mfma_f32_32x32x16_bf16 v[48:63], v[120:123], v[72:75], v[48:63]
    v_mfma_f32_32x32x16_bf16 v[48:63], v[124:127], v[76:79], v[48:63]
    s_nop 15
    v_mul_f32 v136, 0, v32
    v_fma_f32 v136, v33, 0, v136
    v_fma_f32 v136, v34, 0, v136
    v_fma_f32 v136, v35, 0, v136
    v_fma_f32 v136, v36, 0, v136
    v_fma_f32 v136, v37, 0, v136
    v_fma_f32 v136, v38, 0, v136
    v_fma_f32 v136, v39, 0, v136
    v_fma_f32 v136, v40, 0, v136
    v_fma_f32 v136, v41, 0, v136
    v_mul_f32 v137, 0, v48
    v_fma_f32 v137, v49, 0, v137
    v_fma_f32 v137, v50, 0, v137
    v_fma_f32 v137, v51, 0, v137
    v_fma_f32 v137, v52, 0, v137
    v_fma_f32 v137, v53, 0, v137
    v_fma_f32 v137, v54, 0, v137
    v_fma_f32 v137, v55, 0, v137
    v_fma_f32 v137, v56, 0, v137
    v_fma_f32 v137, v57, 0, v137
    v_add_f32 v136, v136, v137
    v_max_f32 v138, v42, v58
    v_min_f32 v139, v42, v58
    v_fma_f32 v136, v42, 0, v136
    v_fma_f32 v136, v58, 0, v136
    v_cmp_eq_f32 s[52:53], 0, v136
    v_cmp_gt_f32 vcc, 0x5f800000, v138
    s_and_b64 s[52:53], s[52:53], vcc
    v_cmp_lt_f32 vcc, 0x1f800000, v139
    s_and_b64 s[52:53], s[52:53], vcc
    s_cmp_eq_u64 s[52:53], -1
    s_cbranch_scc0 K2A_SLOW
K2A_FIN:
    v_and_b32 v137, 31, v135
    v_lshlrev_b32 v137, 4, v137
    v_rcp_f32 v136, v42
    s_add_u32 s43, s41, 0
    s_lshr_b32 s50, s43, 6
    s_and_b32 s51, s43, 63
    v_mul_f32 v32, v32, v136
    v_mul_f32 v33, v33, v136
    v_mul_f32 v34, v34, v136
    v_mul_f32 v35, v35, v136
    v_mul_f32 v36, v36, v136
    v_mul_f32 v37, v37, v136
    v_mul_f32 v38, v38, v136
    v_mul_f32 v39, v39, v136
    v_mul_f32 v40, v40, v136
    v_mul_f32 v41, v41, v136
    v_cvt_pk_bf16_f32 v64, v32, v33
    v_cvt_pk_bf16_f32 v65, v34, v35
    v_cvt_pk_bf16_f32 v66, v36, v37
    v_cvt_pk_bf16_f32 v67, v38, v39
    v_cvt_pk_bf16_f32 v68, v40, v41
    s_mul_i32 s51, s51, 36864
    s_add_u32 s51, s51, 21495808
    s_lshl_b32 s43, s50, 10
    s_add_u32 s43, s43, s51
    buffer_store_dwordx4 v[64:67], v134, s[24:27], s43 offen
    s_lshr_b32 s43, s50, 2
    s_lshl_b32 s43, s43, 9
    s_and_b32 s44, s50, 3
    s_lshl_b32 s44, s44, 2
    s_add_u32 s43, s43, s44
    s_add_u32 s43, s43, s51
    s_add_u32 s43, s43, 32768
    s_mov_b32 exec_hi, 0
    buffer_store_dword v68, v137, s[24:27], s43 offen
    s_mov_b64 exec, -1
    v_rcp_f32 v136, v58
    s_add_u32 s43, s41, 1
    s_lshr_b32 s50, s43, 6
    s_and_b32 s51, s43, 63
    v_mul_f32 v48, v48, v136
    v_mul_f32 v49, v49, v136
    v_mul_f32 v50, v50, v136
    v_mul_f32 v51, v51, v136
    v_mul_f32 v52, v52, v136
    v_mul_f32 v53, v53, v136
    v_mul_f32 v54, v54, v136
    v_mul_f32 v55, v55, v136
    v_mul_f32 v56, v56, v136
    v_mul_f32 v57, v57, v136
    v_cvt_pk_bf16_f32 v72, v48, v49
    v_cvt_pk_bf16_f32 v73, v50, v51
    v_cvt_pk_bf16_f32 v74, v52, v53
    v_cvt_pk_bf16_f32 v75, v54, v55
    v_cvt_pk_bf16_f32 v76, v56, v57
    s_mul_i32 s51, s51, 36864
    s_add_u32 s51, s51, 21495808
    s_lshl_b32 s43, s50, 10
    s_add_u32 s43, s43, s51
    buffer_store_dwordx4 v[72:75], v134, s[24:27], s43 offen
    s_lshr_b32 s43, s50, 2
    s_lshl_b32 s43, s43, 9
    s_and_b32 s44, s50, 3
    s_lshl_b32 s44, s44, 2
    s_add_u32 s43, s43, s44
    s_add_u32 s43, s43, s51
    s_add_u32 s43, s43, 32768
    s_mov_b32 exec_hi, 0
    buffer_store_dword v76, v137, s[24:27], s43 offen
    s_mov_b64 exec, -1
    s_endpgm
K2_GEMM:
    s_load_dwordx2 s[16:17], s[0:1], 88
    s_load_dwordx2 s[18:19], s[0:1], 64
    s_load_dwordx2 s[4:5], s[0:1], 0
    s_load_dwordx2 s[8:9], s[0:1], 32
    v_and_b32 v205, 63, v0
    v_lshrrev_b32 v206, 6, v0
    v_and_b32 v207, 15, v0
    v_readfirstlane_b32 s40, v206
    s_cmp_ge_u32 s3, 240
    s_cbranch_scc1 K2B_IDLE
    v_bfe_u32 v208, v205, 4, 1
    v_lshl_add_u32 v208, v208, 5, v207
    v_lshlrev_b32 v208, 4, v208
    v_lshrrev_b32 v209, 5, v205
    v_lshl_add_u32 v203, v209, 10, v208
    v_lshl_add_u32 v204, v209, 8, v208
    s_and_b32 s43, s3, 7
    s_mul_i32 s43, s43, 30
    s_lshr_b32 s44, s3, 3
    s_add_u32 s43, s43, s44
    s_and_b32 s51, s43, 15
    s_lshr_b32 s43, s43, 4
    s_mul_i32 s49, s43, 11
    s_lshr_b32 s49, s49, 5
    s_mul_i32 s44, s49, 3
    s_sub_u32 s50, s43, s44
    s_mul_i32 s43, s40, 192
    v_add_u32 v209, s43, v205
    v_add_u32 v208, 0, v209
    v_mul_u32_u24 v206, 2731, v208
    v_lshrrev_b32 v206, 16, v206
    v_mul_u32_u24 v207, 24, v206
    v_sub_u32 v207, v208, v207
    v_and_b32 v208, 6, v206
    v_xor_b32 v207, v207, v208
    v_mul_u32_u24 v206, 1152, v206
    v_lshl_add_u32 v200, v207, 4, v206
    v_add_u32 v208, 64, v209
    v_mul_u32_u24 v206, 2731, v208
    v_lshrrev_b32 v206, 16, v206
    v_mul_u32_u24 v207, 24, v206
    v_sub_u32 v207, v208, v207
    v_and_b32 v208, 6, v206
    v_xor_b32 v207, v207, v208
    v_mul_u32_u24 v206, 1152, v206
    v_lshl_add_u32 v201, v207, 4, v206
    v_add_u32 v208, 128, v209
    v_mul_u32_u24 v206, 2731, v208
    v_lshrrev_b32 v206, 16, v206
    v_mul_u32_u24 v207, 24, v206
    v_sub_u32 v207, v208, v207
    v_and_b32 v208, 6, v206
    v_xor_b32 v207, v207, v208
    v_mul_u32_u24 v206, 1152, v206
    v_lshl_add_u32 v202, v207, 4, v206
    s_mul_i32 s43, s49, 29
    s_mul_i32 s45, s43, 36864
    s_mul_i32 s44, s50, 384
    s_add_u32 s45, s45, s44
    s_lshl_b32 s52, s51, 2
    s_add_u32 s52, s52, s40
    s_mul_i32 s46, s52, 144
    s_add_u32 s46, s46, s43
    s_lshl_b32 s46, s46, 11
    s_cmp_eq_u32 s49, 4
    s_cselect_b32 s53, 28, 29
    s_mul_i32 s47, s40, 3072
    v_bfe_u32 v206, v205, 2, 3
    v_lshrrev_b32 v208, 1, v206
    v_lshrrev_b32 v207, 5, v205
    v_lshl_add_u32 v206, v207, 4, v206
    v_mul_u32_u24 v206, 384, v206
    v_and_b32 v207, 3, v205
    v_lshl_add_u32 v206, v207, 3, v206
    v_xor_b32 v207, 0, v208
    v_lshl_add_u32 v192, v207, 5, v206
    v_add_u32 v196, 36864, v192
    v_xor_b32 v207, 1, v208
    v_lshl_add_u32 v193, v207, 5, v206
    v_add_u32 v197, 36864, v193
    v_xor_b32 v207, 2, v208
    v_lshl_add_u32 v194, v207, 5, v206
    v_add_u32 v198, 36864, v194
    v_xor_b32 v207, 3, v208
    v_lshl_add_u32 v195, v207, 5, v206
    v_add_u32 v199, 36864, v195
    s_mov_b32 s48, 0
    s_waitcnt lgkmcnt(0)
    s_mov_b32 s24, s16
    s_and_b32 s25, s17, 0xffff
    s_mov_b32 s26, 0x10000000
    s_mov_b32 s27, 0x00020000
    s_mov_b32 s20, s18
    s_and_b32 s21, s19, 0xffff
    s_mov_b32 s22, 0x510000
    s_mov_b32 s23, 0x00020000
    s_mov_b32 s32, s8
    s_and_b32 s33, s9, 0xffff
    s_mov_b32 s34, 0xa2000
    s_mov_b32 s35, 0x00020000
    v_lshlrev_b32 v215, 7, v205
    s_lshr_b32 s43, s3, 3
    s_lshl_b32 s43, s43, 2
    s_add_u32 s43, s43, s40
    s_mul_i32 s56, s43, 5632
    s_cmp_lg_u32 s49, s40
    s_cbranch_scc1 K2B_NOX
    s_mov_b32 s28, s4
    s_and_b32 s29, s5, 0xffff
    s_mov_b32 s30, 0x240000
    s_mov_b32 s31, 0x00020000
    v_and_b32 v208, 15, v205
    v_mul_u32_u24 v208, 1152, v208
    v_lshrrev_b32 v209, 4, v205
    v_lshl_add_u32 v208, v209, 3, v208
    s_mul_i32 s54, s52, 36864
    s_mul_i32 s43, s50, 384
    s_add_u32 s54, s54, s43
    s_add_u32 s55, s54, 18432
    buffer_load_dwordx2 v[96:97], v208, s[28:31], s54 offen offset:0
    buffer_load_dwordx2 v[98:99], v208, s[28:31], s55 offen offset:0
    buffer_load_dwordx2 v[100:101], v208, s[28:31], s54 offen offset:32
    buffer_load_dwordx2 v[102:103], v208, s[28:31], s55 offen offset:32
    buffer_load_dwordx2 v[104:105], v208, s[28:31], s54 offen offset:64
    buffer_load_dwordx2 v[106:107], v208, s[28:31], s55 offen offset:64
    buffer_load_dwordx2 v[108:109], v208, s[28:31], s54 offen offset:96
    buffer_load_dwordx2 v[110:111], v208, s[28:31], s55 offen offset:96
    buffer_load_dwordx2 v[112:113], v208, s[28:31], s54 offen offset:128
    buffer_load_dwordx2 v[114:115], v208, s[28:31], s55 offen offset:128
    buffer_load_dwordx2 v[116:117], v208, s[28:31], s54 offen offset:160
    buffer_load_dwordx2 v[118:119], v208, s[28:31], s55 offen offset:160
    buffer_load_dwordx2 v[120:121], v208, s[28:31], s54 offen offset:192
    buffer_load_dwordx2 v[122:123], v208, s[28:31], s55 offen offset:192
    buffer_load_dwordx2 v[124:125], v208, s[28:31], s54 offen offset:224
    buffer_load_dwordx2 v[126:127], v208, s[28:31], s55 offen offset:224
    buffer_load_dwordx2 v[128:129], v208, s[28:31], s54 offen offset:256
    buffer_load_dwordx2 v[130:131], v208, s[28:31], s55 offen offset:256
    buffer_load_dwordx2 v[132:133], v208, s[28:31], s54 offen offset:288
    buffer_load_dwordx2 v[134:135], v208, s[28:31], s55 offen offset:288
    buffer_load_dwordx2 v[136:137], v208, s[28:31], s54 offen offset:320
    buffer_load_dwordx2 v[138:139], v208, s[28:31], s55 offen offset:320
    buffer_load_dwordx2 v[140:141], v208, s[28:31], s54 offen offset:352
    buffer_load_dwordx2 v[142:143], v208, s[28:31], s55 offen offset:352
    s_add_u32 m0, s47, 0
    s_nop 0
    buffer_load_dwordx4 v200, s[20:23], s45 offen lds
    s_add_u32 m0, s47, 1024
    s_nop 0
    buffer_load_dwordx4 v201, s[20:23], s45 offen lds
    s_add_u32 m0, s47, 2048
    s_nop 0
    buffer_load_dwordx4 v202, s[20:23], s45 offen lds
    s_add_u32 s45, s45, 36864
    buffer_load_dwordx4 v[144:147], v203, s[24:27], s46 offen
    buffer_load_dwordx4 v[148:151], v203, s[24:27], s46 offen offset:256
    s_add_u32 s46, s46, 2048
    s_add_u32 m0, s47, 12288
    s_nop 0
    buffer_load_dwordx4 v200, s[20:23], s45 offen lds
    s_add_u32 m0, s47, 13312
    s_nop 0
    buffer_load_dwordx4 v201, s[20:23], s45 offen lds
    s_add_u32 m0, s47, 14336
    s_nop 0
    buffer_load_dwordx4 v202, s[20:23], s45 offen lds
    s_add_u32 s45, s45, 36864
    buffer_load_dwordx4 v[152:155], v203, s[24:27], s46 offen
    buffer_load_dwordx4 v[156:159], v203, s[24:27], s46 offen offset:256
    s_add_u32 s46, s46, 2048
    s_add_u32 m0, s47, 24576
    s_nop 0
    buffer_load_dwordx4 v200, s[20:23], s45 offen lds
    s_add_u32 m0, s47, 25600
    s_nop 0
    buffer_load_dwordx4 v201, s[20:23], s45 offen lds
    s_add_u32 m0, s47, 26624
    s_nop 0
    buffer_load_dwordx4 v202, s[20:23], s45 offen lds
    s_add_u32 s45, s45, 36864
    buffer_load_dwordx4 v[160:163], v203, s[24:27], s46 offen
    buffer_load_dwordx4 v[164:167], v203, s[24:27], s46 offen offset:256
    s_add_u32 s46, s46, 2048
    s_add_u32 m0, s47, 36864
    s_nop 0
    buffer_load_dwordx4 v200, s[20:23], s45 offen lds
    s_add_u32 m0, s47, 37888
    s_nop 0
    buffer_load_dwordx4 v201, s[20:23], s45 offen lds
    s_add_u32 m0, s47, 38912
    s_nop 0
    buffer_load_dwordx4 v202, s[20:23], s45 offen lds
    s_add_u32 s45, s45, 36864
    buffer_load_dwordx4 v[168:171], v203, s[24:27], s46 offen
    buffer_load_dwordx4 v[172:175], v203, s[24:27], s46 offen offset:256
    s_add_u32 s46, s46, 2048
    s_add_u32 m0, s47, 49152
    s_nop 0
    buffer_load_dwordx4 v200, s[20:23], s45 offen lds
    s_add_u32 m0, s47, 50176
    s_nop 0
    buffer_load_dwordx4 v201, s[20:23], s45 offen lds
    s_add_u32 m0, s47, 51200
    s_nop 0
    buffer_load_dwordx4 v202, s[20:23], s45 offen lds
    s_add_u32 s45, s45, 36864
    buffer_load_dwordx4 v[176:179], v203, s[24:27], s46 offen
    buffer_load_dwordx4 v[180:183], v203, s[24:27], s46 offen offset:256
    s_add_u32 s46, s46, 2048
    s_waitcnt vmcnt(25)
    s_setprio 3
    v_lshlrev_b32 v0, 16, v96
    v_and_b32 v1, 0xffff0000, v96
    v_lshlrev_b32 v2, 16, v97
    v_and_b32 v3, 0xffff0000, v97
    v_lshlrev_b32 v4, 16, v98
    v_and_b32 v5, 0xffff0000, v98
    v_lshlrev_b32 v6, 16, v99
    v_and_b32 v7, 0xffff0000, v99
    v_lshlrev_b32 v8, 16, v100
    v_and_b32 v9, 0xffff0000, v100
    v_lshlrev_b32 v10, 16, v101
    v_and_b32 v11, 0xffff0000, v101
    v_lshlrev_b32 v12, 16, v102
    v_and_b32 v13, 0xffff0000, v102
    v_lshlrev_b32 v14, 16, v103
    v_and_b32 v15, 0xffff0000, v103
    v_lshlrev_b32 v16, 16, v104
    v_and_b32 v17, 0xffff0000, v104
    v_lshlrev_b32 v18, 16, v105
    v_and_b32 v19, 0xffff0000, v105
    v_lshlrev_b32 v20, 16, v106
    v_and_b32 v21, 0xffff0000, v106
    v_lshlrev_b32 v22, 16, v107
    v_and_b32 v23, 0xffff0000, v107
    v_lshlrev_b32 v24, 16, v108
    v_and_b32 v25, 0xffff0000, v108
    v_lshlrev_b32 v26, 16, v109
    v_and_b32 v27, 0xffff0000, v109
    v_lshlrev_b32 v28, 16, v110
    v_and_b32 v29, 0xffff0000, v110
    v_lshlrev_b32 v30, 16, v111
    v_and_b32 v31, 0xffff0000, v111
    v_lshlrev_b32 v32, 16, v112
    v_and_b32 v33, 0xffff0000, v112
    v_lshlrev_b32 v34, 16, v113
    v_and_b32 v35, 0xffff0000, v113
    v_lshlrev_b32 v36, 16, v114
    v_and_b32 v37, 0xffff0000, v114
    v_lshlrev_b32 v38, 16, v115
    v_and_b32 v39, 0xffff0000, v115
    v_lshlrev_b32 v40, 16, v116
    v_and_b32 v41, 0xffff0000, v116
    v_lshlrev_b32 v42, 16, v117
    v_and_b32 v43, 0xffff0000, v117
    v_lshlrev_b32 v44, 16, v118
    v_and_b32 v45, 0xffff0000, v118
    v_lshlrev_b32 v46, 16, v119
    v_and_b32 v47, 0xffff0000, v119
    v_lshlrev_b32 v48, 16, v120
    v_and_b32 v49, 0xffff0000, v120
    v_lshlrev_b32 v50, 16, v121
    v_and_b32 v51, 0xffff0000, v121
    v_lshlrev_b32 v52, 16, v122
    v_and_b32 v53, 0xffff0000, v122
    v_lshlrev_b32 v54, 16, v123
    v_and_b32 v55, 0xffff0000, v123
    v_lshlrev_b32 v56, 16, v124
    v_and_b32 v57, 0xffff0000, v124
    v_lshlrev_b32 v58, 16, v125
    v_and_b32 v59, 0xffff0000, v125
    v_lshlrev_b32 v60, 16, v126
    v_and_b32 v61, 0xffff0000, v126
    v_lshlrev_b32 v62, 16, v127
    v_and_b32 v63, 0xffff0000, v127
    v_lshlrev_b32 v64, 16, v128
    v_and_b32 v65, 0xffff0000, v128
    v_lshlrev_b32 v66, 16, v129
    v_and_b32 v67, 0xffff0000, v129
    v_lshlrev_b32 v68, 16, v130
    v_and_b32 v69, 0xffff0000, v130
    v_lshlrev_b32 v70, 16, v131
    v_and_b32 v71, 0xffff0000, v131
    v_lshlrev_b32 v72, 16, v132
    v_and_b32 v73, 0xffff0000, v132
    v_lshlrev_b32 v74, 16, v133
    v_and_b32 v75, 0xffff0000, v133
    v_lshlrev_b32 v76, 16, v134
    v_and_b32 v77, 0xffff0000, v134
    v_lshlrev_b32 v78, 16, v135
    v_and_b32 v79, 0xffff0000, v135
    v_lshlrev_b32 v80, 16, v136
    v_and_b32 v81, 0xffff0000, v136
    v_lshlrev_b32 v82, 16, v137
    v_and_b32 v83, 0xffff0000, v137
    v_lshlrev_b32 v84, 16, v138
    v_and_b32 v85, 0xffff0000, v138
    v_lshlrev_b32 v86, 16, v139
    v_and_b32 v87, 0xffff0000, v139
    v_lshlrev_b32 v88, 16, v140
    v_and_b32 v89, 0xffff0000, v140
    v_lshlrev_b32 v90, 16, v141
    v_and_b32 v91, 0xffff0000, v141
    v_lshlrev_b32 v92, 16, v142
    v_and_b32 v93, 0xffff0000, v142
    v_lshlrev_b32 v94, 16, v143
    v_and_b32 v95, 0xffff0000, v143
    s_setprio 0
    s_branch K2B_GO
K2B_NOX:
    s_add_u32 m0, s47, 0
    s_nop 0
    buffer_load_dwordx4 v200, s[20:23], s45 offen lds
    s_add_u32 m0, s47, 1024
    s_nop 0
    buffer_load_dwordx4 v201, s[20:23], s45 offen lds
    s_add_u32 m0, s47, 2048
    s_nop 0
    buffer_load_dwordx4 v202, s[20:23], s45 offen lds
    s_add_u32 s45, s45, 36864
    buffer_load_dwordx4 v[144:147], v203, s[24:27], s46 offen
    buffer_load_dwordx4 v[148:151], v203, s[24:27], s46 offen offset:256
    s_add_u32 s46, s46, 2048
    s_add_u32 m0, s47, 12288
    s_nop 0
    buffer_load_dwordx4 v200, s[20:23], s45 offen lds
    s_add_u32 m0, s47, 13312
    s_nop 0
    buffer_load_dwordx4 v201, s[20:23], s45 offen lds
    s_add_u32 m0, s47, 14336
    s_nop 0
    buffer_load_dwordx4 v202, s[20:23], s45 offen lds
    s_add_u32 s45, s45, 36864
    buffer_load_dwordx4 v[152:155], v203, s[24:27], s46 offen
    buffer_load_dwordx4 v[156:159], v203, s[24:27], s46 offen offset:256
    s_add_u32 s46, s46, 2048
    s_setprio 3
    v_mov_b64 v[0:1], 0
    v_mov_b64 v[2:3], 0
    v_mov_b64 v[4:5], 0
    v_mov_b64 v[6:7], 0
    v_mov_b64 v[8:9], 0
    v_mov_b64 v[10:11], 0
    v_mov_b64 v[12:13], 0
    v_mov_b64 v[14:15], 0
    v_mov_b64 v[16:17], 0
    v_mov_b64 v[18:19], 0
    v_mov_b64 v[20:21], 0
    v_mov_b64 v[22:23], 0
    v_mov_b64 v[24:25], 0
    v_mov_b64 v[26:27], 0
    v_mov_b64 v[28:29], 0
    v_mov_b64 v[30:31], 0
    v_mov_b64 v[32:33], 0
    v_mov_b64 v[34:35], 0
    v_mov_b64 v[36:37], 0
    v_mov_b64 v[38:39], 0
    v_mov_b64 v[40:41], 0
    v_mov_b64 v[42:43], 0
    v_mov_b64 v[44:45], 0
    v_mov_b64 v[46:47], 0
    v_mov_b64 v[48:49], 0
    v_mov_b64 v[50:51], 0
    v_mov_b64 v[52:53], 0
    v_mov_b64 v[54:55], 0
    v_mov_b64 v[56:57], 0
    v_mov_b64 v[58:59], 0
    v_mov_b64 v[60:61], 0
    v_mov_b64 v[62:63], 0
    v_mov_b64 v[64:65], 0
    v_mov_b64 v[66:67], 0
    v_mov_b64 v[68:69], 0
    v_mov_b64 v[70:71], 0
    v_mov_b64 v[72:73], 0
    v_mov_b64 v[74:75], 0
    v_mov_b64 v[76:77], 0
    v_mov_b64 v[78:79], 0
    v_mov_b64 v[80:81], 0
    v_mov_b64 v[82:83], 0
    v_mov_b64 v[84:85], 0
    v_mov_b64 v[86:87], 0
    v_mov_b64 v[88:89], 0
    v_mov_b64 v[90:91], 0
    v_mov_b64 v[92:93], 0
    v_mov_b64 v[94:95], 0
    s_setprio 0
    s_add_u32 m0, s47, 24576
    s_nop 0
    buffer_load_dwordx4 v200, s[20:23], s45 offen lds
    s_add_u32 m0, s47, 25600
    s_nop 0
    buffer_load_dwordx4 v201, s[20:23], s45 offen lds
    s_add_u32 m0, s47, 26624
    s_nop 0
    buffer_load_dwordx4 v202, s[20:23], s45 offen lds
    s_add_u32 s45, s45, 36864
    buffer_load_dwordx4 v[160:163], v203, s[24:27], s46 offen
    buffer_load_dwordx4 v[164:167], v203, s[24:27], s46 offen offset:256
    s_add_u32 s46, s46, 2048
    s_add_u32 m0, s47, 36864
    s_nop 0
    buffer_load_dwordx4 v200, s[20:23], s45 offen lds
    s_add_u32 m0, s47, 37888
    s_nop 0
    buffer_load_dwordx4 v201, s[20:23], s45 offen lds
    s_add_u32 m0, s47, 38912
    s_nop 0
    buffer_load_dwordx4 v202, s[20:23], s45 offen lds
    s_add_u32 s45, s45, 36864
    buffer_load_dwordx4 v[168:171], v203, s[24:27], s46 offen
    buffer_load_dwordx4 v[172:175], v203, s[24:27], s46 offen offset:256
    s_add_u32 s46, s46, 2048
    s_add_u32 m0, s47, 49152
    s_nop 0
    buffer_load_dwordx4 v200, s[20:23], s45 offen lds
    s_add_u32 m0, s47, 50176
    s_nop 0
    buffer_load_dwordx4 v201, s[20:23], s45 offen lds
    s_add_u32 m0, s47, 51200
    s_nop 0
    buffer_load_dwordx4 v202, s[20:23], s45 offen lds
    s_add_u32 s45, s45, 36864
    buffer_load_dwordx4 v[176:179], v203, s[24:27], s46 offen
    buffer_load_dwordx4 v[180:183], v203, s[24:27], s46 offen offset:256
    s_add_u32 s46, s46, 2048
K2B_GO:
    s_waitcnt vmcnt(20)
    s_barrier
    ds_read_b64_tr_b16 v[96:97], v192 offset:0
    ds_read_b64_tr_b16 v[98:99], v192 offset:3072
    ds_read_b64_tr_b16 v[100:101], v193 offset:0
    ds_read_b64_tr_b16 v[102:103], v193 offset:3072
    ds_read_b64_tr_b16 v[104:105], v194 offset:0
    ds_read_b64_tr_b16 v[106:107], v194 offset:3072
    ds_read_b64_tr_b16 v[108:109], v195 offset:0
    ds_read_b64_tr_b16 v[110:111], v195 offset:3072
    ds_read_b64_tr_b16 v[112:113], v192 offset:128
    ds_read_b64_tr_b16 v[114:115], v192 offset:3200
    ds_read_b64_tr_b16 v[116:117], v193 offset:128
    ds_read_b64_tr_b16 v[118:119], v193 offset:3200
.p2align 6
K2B_LOOP:
    s_waitcnt lgkmcnt(0)
    s_waitcnt vmcnt(15)
    s_barrier
    v_mfma_f32_16x16x32_bf16 v[0:3], v[96:99], v[144:147], v[0:3]
    ds_read_b64_tr_b16 v[120:121], v194 offset:128
    ds_read_b64_tr_b16 v[122:123], v194 offset:3200
    v_mfma_f32_16x16x32_bf16 v[4:7], v[96:99], v[148:151], v[4:7]
    ds_read_b64_tr_b16 v[124:125], v195 offset:128
    v_mfma_f32_16x16x32_bf16 v[8:11], v[100:103], v[144:147], v[8:11]
    ds_read_b64_tr_b16 v[126:127], v195 offset:3200
    ds_read_b64_tr_b16 v[128:129], v192 offset:256
    v_mfma_f32_16x16x32_bf16 v[12:15], v[100:103], v[148:151], v[12:15]
    ds_read_b64_tr_b16 v[130:131], v192 offset:3328
    v_mfma_f32_16x16x32_bf16 v[16:19], v[104:107], v[144:147], v[16:19]
    ds_read_b64_tr_b16 v[132:133], v193 offset:256
    ds_read_b64_tr_b16 v[134:135], v193 offset:3328
    v_mfma_f32_16x16x32_bf16 v[20:23], v[104:107], v[148:151], v[20:23]
    ds_read_b64_tr_b16 v[136:137], v194 offset:256
    v_mfma_f32_16x16x32_bf16 v[24:27], v[108:111], v[144:147], v[24:27]
    ds_read_b64_tr_b16 v[138:139], v194 offset:3328
    ds_read_b64_tr_b16 v[140:141], v195 offset:256
    v_mfma_f32_16x16x32_bf16 v[28:31], v[108:111], v[148:151], v[28:31]
    ds_read_b64_tr_b16 v[142:143], v195 offset:3328
    v_mfma_f32_16x16x32_bf16 v[32:35], v[112:115], v[144:147], v[32:35]
    s_add_u32 s43, s48, 5
    s_cmp_ge_u32 s43, s53
    s_cselect_b32 s45, 0x70000000, s45
    s_cselect_b32 s46, 0x70000000, s46
    s_add_u32 m0, s47, 61440
    s_nop 0
    buffer_load_dwordx4 v200, s[20:23], s45 offen lds
    v_mfma_f32_16x16x32_bf16 v[36:39], v[112:115], v[148:151], v[36:39]
    s_add_u32 m0, s47, 62464
    s_nop 0
    buffer_load_dwordx4 v201, s[20:23], s45 offen lds
    v_mfma_f32_16x16x32_bf16 v[40:43], v[116:119], v[144:147], v[40:43]
    s_add_u32 m0, s47, 63488
    s_nop 0
    buffer_load_dwordx4 v202, s[20:23], s45 offen lds
    s_add_u32 s45, s45, 36864
    v_mfma_f32_16x16x32_bf16 v[44:47], v[116:119], v[148:151], v[44:47]
    s_waitcnt lgkmcnt(0)
    v_mfma_f32_16x16x32_bf16 v[48:51], v[120:123], v[144:147], v[48:51]
    ds_read_b64_tr_b16 v[96:97], v192 offset:12288
    ds_read_b64_tr_b16 v[98:99], v192 offset:15360
    v_mfma_f32_16x16x32_bf16 v[52:55], v[120:123], v[148:151], v[52:55]
    ds_read_b64_tr_b16 v[100:101], v193 offset:12288
    v_mfma_f32_16x16x32_bf16 v[56:59], v[124:127], v[144:147], v[56:59]
    ds_read_b64_tr_b16 v[102:103], v193 offset:15360
    ds_read_b64_tr_b16 v[104:105], v194 offset:12288
    v_mfma_f32_16x16x32_bf16 v[60:63], v[124:127], v[148:151], v[60:63]
    ds_read_b64_tr_b16 v[106:107], v194 offset:15360
    v_mfma_f32_16x16x32_bf16 v[64:67], v[128:131], v[144:147], v[64:67]
    ds_read_b64_tr_b16 v[108:109], v195 offset:12288
    ds_read_b64_tr_b16 v[110:111], v195 offset:15360
    v_mfma_f32_16x16x32_bf16 v[68:71], v[128:131], v[148:151], v[68:71]
    ds_read_b64_tr_b16 v[112:113], v192 offset:12416
    v_mfma_f32_16x16x32_bf16 v[72:75], v[132:135], v[144:147], v[72:75]
    ds_read_b64_tr_b16 v[114:115], v192 offset:15488
    ds_read_b64_tr_b16 v[116:117], v193 offset:12416
    v_mfma_f32_16x16x32_bf16 v[76:79], v[132:135], v[148:151], v[76:79]
    ds_read_b64_tr_b16 v[118:119], v193 offset:15488
    v_mfma_f32_16x16x32_bf16 v[80:83], v[136:139], v[144:147], v[80:83]
    buffer_load_dwordx4 v[184:187], v203, s[24:27], s46 offen
    v_mfma_f32_16x16x32_bf16 v[84:87], v[136:139], v[148:151], v[84:87]
    buffer_load_dwordx4 v[188:191], v203, s[24:27], s46 offen offset:256
    s_add_u32 s46, s46, 2048
    v_mfma_f32_16x16x32_bf16 v[88:91], v[140:143], v[144:147], v[88:91]
    v_mfma_f32_16x16x32_bf16 v[92:95], v[140:143], v[148:151], v[92:95]
    s_add_u32 s48, s48, 1
    s_cmp_ge_u32 s48, s53
    s_cbranch_scc1 K2B_DONE
    s_waitcnt lgkmcnt(0)
    s_waitcnt vmcnt(15)
    s_barrier
    v_mfma_f32_16x16x32_bf16 v[0:3], v[96:99], v[152:155], v[0:3]
    ds_read_b64_tr_b16 v[120:121], v194 offset:12416
    ds_read_b64_tr_b16 v[122:123], v194 offset:15488
    v_mfma_f32_16x16x32_bf16 v[4:7], v[96:99], v[156:159], v[4:7]
    ds_read_b64_tr_b16 v[124:125], v195 offset:12416
    v_mfma_f32_16x16x32_bf16 v[8:11], v[100:103], v[152:155], v[8:11]
    ds_read_b64_tr_b16 v[126:127], v195 offset:15488
    ds_read_b64_tr_b16 v[128:129], v192 offset:12544
    v_mfma_f32_16x16x32_bf16 v[12:15], v[100:103], v[156:159], v[12:15]
    ds_read_b64_tr_b16 v[130:131], v192 offset:15616
    v_mfma_f32_16x16x32_bf16 v[16:19], v[104:107], v[152:155], v[16:19]
    ds_read_b64_tr_b16 v[132:133], v193 offset:12544
    ds_read_b64_tr_b16 v[134:135], v193 offset:15616
    v_mfma_f32_16x16x32_bf16 v[20:23], v[104:107], v[156:159], v[20:23]
    ds_read_b64_tr_b16 v[136:137], v194 offset:12544
    v_mfma_f32_16x16x32_bf16 v[24:27], v[108:111], v[152:155], v[24:27]
    ds_read_b64_tr_b16 v[138:139], v194 offset:15616
    ds_read_b64_tr_b16 v[140:141], v195 offset:12544
    v_mfma_f32_16x16x32_bf16 v[28:31], v[108:111], v[156:159], v[28:31]
    ds_read_b64_tr_b16 v[142:143], v195 offset:15616
    v_mfma_f32_16x16x32_bf16 v[32:35], v[112:115], v[152:155], v[32:35]
    s_add_u32 s43, s48, 5
    s_cmp_ge_u32 s43, s53
    s_cselect_b32 s45, 0x70000000, s45
    s_cselect_b32 s46, 0x70000000, s46
    s_add_u32 m0, s47, 0
    s_nop 0
    buffer_load_dwordx4 v200, s[20:23], s45 offen lds
    v_mfma_f32_16x16x32_bf16 v[36:39], v[112:115], v[156:159], v[36:39]
    s_add_u32 m0, s47, 1024
    s_nop 0
    buffer_load_dwordx4 v201, s[20:23], s45 offen lds
    v_mfma_f32_16x16x32_bf16 v[40:43], v[116:119], v[152:155], v[40:43]
    s_add_u32 m0, s47, 2048
    s_nop 0
    buffer_load_dwordx4 v202, s[20:23], s45 offen lds
    s_add_u32 s45, s45, 36864
    v_mfma_f32_16x16x32_bf16 v[44:47], v[116:119], v[156:159], v[44:47]
    s_waitcnt lgkmcnt(0)
    v_mfma_f32_16x16x32_bf16 v[48:51], v[120:123], v[152:155], v[48:51]
    ds_read_b64_tr_b16 v[96:97], v192 offset:24576
    ds_read_b64_tr_b16 v[98:99], v192 offset:27648
    v_mfma_f32_16x16x32_bf16 v[52:55], v[120:123], v[156:159], v[52:55]
    ds_read_b64_tr_b16 v[100:101], v193 offset:24576
    v_mfma_f32_16x16x32_bf16 v[56:59], v[124:127], v[152:155], v[56:59]
    ds_read_b64_tr_b16 v[102:103], v193 offset:27648
    ds_read_b64_tr_b16 v[104:105], v194 offset:24576
    v_mfma_f32_16x16x32_bf16 v[60:63], v[124:127], v[156:159], v[60:63]
    ds_read_b64_tr_b16 v[106:107], v194 offset:27648
    v_mfma_f32_16x16x32_bf16 v[64:67], v[128:131], v[152:155], v[64:67]
    ds_read_b64_tr_b16 v[108:109], v195 offset:24576
    ds_read_b64_tr_b16 v[110:111], v195 offset:27648
    v_mfma_f32_16x16x32_bf16 v[68:71], v[128:131], v[156:159], v[68:71]
    ds_read_b64_tr_b16 v[112:113], v192 offset:24704
    v_mfma_f32_16x16x32_bf16 v[72:75], v[132:135], v[152:155], v[72:75]
    ds_read_b64_tr_b16 v[114:115], v192 offset:27776
    ds_read_b64_tr_b16 v[116:117], v193 offset:24704
    v_mfma_f32_16x16x32_bf16 v[76:79], v[132:135], v[156:159], v[76:79]
    ds_read_b64_tr_b16 v[118:119], v193 offset:27776
    v_mfma_f32_16x16x32_bf16 v[80:83], v[136:139], v[152:155], v[80:83]
    buffer_load_dwordx4 v[144:147], v203, s[24:27], s46 offen
    v_mfma_f32_16x16x32_bf16 v[84:87], v[136:139], v[156:159], v[84:87]
    buffer_load_dwordx4 v[148:151], v203, s[24:27], s46 offen offset:256
    s_add_u32 s46, s46, 2048
    v_mfma_f32_16x16x32_bf16 v[88:91], v[140:143], v[152:155], v[88:91]
    v_mfma_f32_16x16x32_bf16 v[92:95], v[140:143], v[156:159], v[92:95]
    s_add_u32 s48, s48, 1
    s_cmp_ge_u32 s48, s53
    s_cbranch_scc1 K2B_DONE
    s_waitcnt lgkmcnt(0)
    s_waitcnt vmcnt(15)
    s_barrier
    v_mfma_f32_16x16x32_bf16 v[0:3], v[96:99], v[160:163], v[0:3]
    ds_read_b64_tr_b16 v[120:121], v194 offset:24704
    ds_read_b64_tr_b16 v[122:123], v194 offset:27776
    v_mfma_f32_16x16x32_bf16 v[4:7], v[96:99], v[164:167], v[4:7]
    ds_read_b64_tr_b16 v[124:125], v195 offset:24704
    v_mfma_f32_16x16x32_bf16 v[8:11], v[100:103], v[160:163], v[8:11]
    ds_read_b64_tr_b16 v[126:127], v195 offset:27776
    ds_read_b64_tr_b16 v[128:129], v192 offset:24832
    v_mfma_f32_16x16x32_bf16 v[12:15], v[100:103], v[164:167], v[12:15]
    ds_read_b64_tr_b16 v[130:131], v192 offset:27904
    v_mfma_f32_16x16x32_bf16 v[16:19], v[104:107], v[160:163], v[16:19]
    ds_read_b64_tr_b16 v[132:133], v193 offset:24832
    ds_read_b64_tr_b16 v[134:135], v193 offset:27904
    v_mfma_f32_16x16x32_bf16 v[20:23], v[104:107], v[164:167], v[20:23]
    ds_read_b64_tr_b16 v[136:137], v194 offset:24832
    v_mfma_f32_16x16x32_bf16 v[24:27], v[108:111], v[160:163], v[24:27]
    ds_read_b64_tr_b16 v[138:139], v194 offset:27904
    ds_read_b64_tr_b16 v[140:141], v195 offset:24832
    v_mfma_f32_16x16x32_bf16 v[28:31], v[108:111], v[164:167], v[28:31]
    ds_read_b64_tr_b16 v[142:143], v195 offset:27904
    v_mfma_f32_16x16x32_bf16 v[32:35], v[112:115], v[160:163], v[32:35]
    s_add_u32 s43, s48, 5
    s_cmp_ge_u32 s43, s53
    s_cselect_b32 s45, 0x70000000, s45
    s_cselect_b32 s46, 0x70000000, s46
    s_add_u32 m0, s47, 12288
    s_nop 0
    buffer_load_dwordx4 v200, s[20:23], s45 offen lds
    v_mfma_f32_16x16x32_bf16 v[36:39], v[112:115], v[164:167], v[36:39]
    s_add_u32 m0, s47, 13312
    s_nop 0
    buffer_load_dwordx4 v201, s[20:23], s45 offen lds
    v_mfma_f32_16x16x32_bf16 v[40:43], v[116:119], v[160:163], v[40:43]
    s_add_u32 m0, s47, 14336
    s_nop 0
    buffer_load_dwordx4 v202, s[20:23], s45 offen lds
    s_add_u32 s45, s45, 36864
    v_mfma_f32_16x16x32_bf16 v[44:47], v[116:119], v[164:167], v[44:47]
    s_waitcnt lgkmcnt(0)
    v_mfma_f32_16x16x32_bf16 v[48:51], v[120:123], v[160:163], v[48:51]
    ds_read_b64_tr_b16 v[96:97], v196 offset:0
    ds_read_b64_tr_b16 v[98:99], v196 offset:3072
    v_mfma_f32_16x16x32_bf16 v[52:55], v[120:123], v[164:167], v[52:55]
    ds_read_b64_tr_b16 v[100:101], v197 offset:0
    v_mfma_f32_16x16x32_bf16 v[56:59], v[124:127], v[160:163], v[56:59]
    ds_read_b64_tr_b16 v[102:103], v197 offset:3072
    ds_read_b64_tr_b16 v[104:105], v198 offset:0
    v_mfma_f32_16x16x32_bf16 v[60:63], v[124:127], v[164:167], v[60:63]
    ds_read_b64_tr_b16 v[106:107], v198 offset:3072
    v_mfma_f32_16x16x32_bf16 v[64:67], v[128:131], v[160:163], v[64:67]
    ds_read_b64_tr_b16 v[108:109], v199 offset:0
    ds_read_b64_tr_b16 v[110:111], v199 offset:3072
    v_mfma_f32_16x16x32_bf16 v[68:71], v[128:131], v[164:167], v[68:71]
    ds_read_b64_tr_b16 v[112:113], v196 offset:128
    v_mfma_f32_16x16x32_bf16 v[72:75], v[132:135], v[160:163], v[72:75]
    ds_read_b64_tr_b16 v[114:115], v196 offset:3200
    ds_read_b64_tr_b16 v[116:117], v197 offset:128
    v_mfma_f32_16x16x32_bf16 v[76:79], v[132:135], v[164:167], v[76:79]
    ds_read_b64_tr_b16 v[118:119], v197 offset:3200
    v_mfma_f32_16x16x32_bf16 v[80:83], v[136:139], v[160:163], v[80:83]
    buffer_load_dwordx4 v[152:155], v203, s[24:27], s46 offen
    v_mfma_f32_16x16x32_bf16 v[84:87], v[136:139], v[164:167], v[84:87]
    buffer_load_dwordx4 v[156:159], v203, s[24:27], s46 offen offset:256
    s_add_u32 s46, s46, 2048
    v_mfma_f32_16x16x32_bf16 v[88:91], v[140:143], v[160:163], v[88:91]
    v_mfma_f32_16x16x32_bf16 v[92:95], v[140:143], v[164:167], v[92:95]
    s_add_u32 s48, s48, 1
    s_cmp_ge_u32 s48, s53
    s_cbranch_scc1 K2B_DONE
    s_waitcnt lgkmcnt(0)
    s_waitcnt vmcnt(15)
    s_barrier
    v_mfma_f32_16x16x32_bf16 v[0:3], v[96:99], v[168:171], v[0:3]
    ds_read_b64_tr_b16 v[120:121], v198 offset:128
    ds_read_b64_tr_b16 v[122:123], v198 offset:3200
    v_mfma_f32_16x16x32_bf16 v[4:7], v[96:99], v[172:175], v[4:7]
    ds_read_b64_tr_b16 v[124:125], v199 offset:128
    v_mfma_f32_16x16x32_bf16 v[8:11], v[100:103], v[168:171], v[8:11]
    ds_read_b64_tr_b16 v[126:127], v199 offset:3200
    ds_read_b64_tr_b16 v[128:129], v196 offset:256
    v_mfma_f32_16x16x32_bf16 v[12:15], v[100:103], v[172:175], v[12:15]
    ds_read_b64_tr_b16 v[130:131], v196 offset:3328
    v_mfma_f32_16x16x32_bf16 v[16:19], v[104:107], v[168:171], v[16:19]
    ds_read_b64_tr_b16 v[132:133], v197 offset:256
    ds_read_b64_tr_b16 v[134:135], v197 offset:3328
    v_mfma_f32_16x16x32_bf16 v[20:23], v[104:107], v[172:175], v[20:23]
    ds_read_b64_tr_b16 v[136:137], v198 offset:256
    v_mfma_f32_16x16x32_bf16 v[24:27], v[108:111], v[168:171], v[24:27]
    ds_read_b64_tr_b16 v[138:139], v198 offset:3328
    ds_read_b64_tr_b16 v[140:141], v199 offset:256
    v_mfma_f32_16x16x32_bf16 v[28:31], v[108:111], v[172:175], v[28:31]
    ds_read_b64_tr_b16 v[142:143], v199 offset:3328
    v_mfma_f32_16x16x32_bf16 v[32:35], v[112:115], v[168:171], v[32:35]
    s_add_u32 s43, s48, 5
    s_cmp_ge_u32 s43, s53
    s_cselect_b32 s45, 0x70000000, s45
    s_cselect_b32 s46, 0x70000000, s46
    s_add_u32 m0, s47, 24576
    s_nop 0
    buffer_load_dwordx4 v200, s[20:23], s45 offen lds
    v_mfma_f32_16x16x32_bf16 v[36:39], v[112:115], v[172:175], v[36:39]
    s_add_u32 m0, s47, 25600
    s_nop 0
    buffer_load_dwordx4 v201, s[20:23], s45 offen lds
    v_mfma_f32_16x16x32_bf16 v[40:43], v[116:119], v[168:171], v[40:43]
    s_add_u32 m0, s47, 26624
    s_nop 0
    buffer_load_dwordx4 v202, s[20:23], s45 offen lds
    s_add_u32 s45, s45, 36864
    v_mfma_f32_16x16x32_bf16 v[44:47], v[116:119], v[172:175], v[44:47]
    s_waitcnt lgkmcnt(0)
    v_mfma_f32_16x16x32_bf16 v[48:51], v[120:123], v[168:171], v[48:51]
    ds_read_b64_tr_b16 v[96:97], v196 offset:12288
    ds_read_b64_tr_b16 v[98:99], v196 offset:15360
    v_mfma_f32_16x16x32_bf16 v[52:55], v[120:123], v[172:175], v[52:55]
    ds_read_b64_tr_b16 v[100:101], v197 offset:12288
    v_mfma_f32_16x16x32_bf16 v[56:59], v[124:127], v[168:171], v[56:59]
    ds_read_b64_tr_b16 v[102:103], v197 offset:15360
    ds_read_b64_tr_b16 v[104:105], v198 offset:12288
    v_mfma_f32_16x16x32_bf16 v[60:63], v[124:127], v[172:175], v[60:63]
    ds_read_b64_tr_b16 v[106:107], v198 offset:15360
    v_mfma_f32_16x16x32_bf16 v[64:67], v[128:131], v[168:171], v[64:67]
    ds_read_b64_tr_b16 v[108:109], v199 offset:12288
    ds_read_b64_tr_b16 v[110:111], v199 offset:15360
    v_mfma_f32_16x16x32_bf16 v[68:71], v[128:131], v[172:175], v[68:71]
    ds_read_b64_tr_b16 v[112:113], v196 offset:12416
    v_mfma_f32_16x16x32_bf16 v[72:75], v[132:135], v[168:171], v[72:75]
    ds_read_b64_tr_b16 v[114:115], v196 offset:15488
    ds_read_b64_tr_b16 v[116:117], v197 offset:12416
    v_mfma_f32_16x16x32_bf16 v[76:79], v[132:135], v[172:175], v[76:79]
    ds_read_b64_tr_b16 v[118:119], v197 offset:15488
    v_mfma_f32_16x16x32_bf16 v[80:83], v[136:139], v[168:171], v[80:83]
    buffer_load_dwordx4 v[160:163], v203, s[24:27], s46 offen
    v_mfma_f32_16x16x32_bf16 v[84:87], v[136:139], v[172:175], v[84:87]
    buffer_load_dwordx4 v[164:167], v203, s[24:27], s46 offen offset:256
    s_add_u32 s46, s46, 2048
    v_mfma_f32_16x16x32_bf16 v[88:91], v[140:143], v[168:171], v[88:91]
    v_mfma_f32_16x16x32_bf16 v[92:95], v[140:143], v[172:175], v[92:95]
    s_add_u32 s48, s48, 1
    s_cmp_ge_u32 s48, s53
    s_cbranch_scc1 K2B_DONE
    s_waitcnt lgkmcnt(0)
    s_waitcnt vmcnt(15)
    s_barrier
    v_mfma_f32_16x16x32_bf16 v[0:3], v[96:99], v[176:179], v[0:3]
    ds_read_b64_tr_b16 v[120:121], v198 offset:12416
    ds_read_b64_tr_b16 v[122:123], v198 offset:15488
    v_mfma_f32_16x16x32_bf16 v[4:7], v[96:99], v[180:183], v[4:7]
    ds_read_b64_tr_b16 v[124:125], v199 offset:12416
    v_mfma_f32_16x16x32_bf16 v[8:11], v[100:103], v[176:179], v[8:11]
    ds_read_b64_tr_b16 v[126:127], v199 offset:15488
    ds_read_b64_tr_b16 v[128:129], v196 offset:12544
    v_mfma_f32_16x16x32_bf16 v[12:15], v[100:103], v[180:183], v[12:15]
    ds_read_b64_tr_b16 v[130:131], v196 offset:15616
    v_mfma_f32_16x16x32_bf16 v[16:19], v[104:107], v[176:179], v[16:19]
    ds_read_b64_tr_b16 v[132:133], v197 offset:12544
    ds_read_b64_tr_b16 v[134:135], v197 offset:15616
    v_mfma_f32_16x16x32_bf16 v[20:23], v[104:107], v[180:183], v[20:23]
    ds_read_b64_tr_b16 v[136:137], v198 offset:12544
    v_mfma_f32_16x16x32_bf16 v[24:27], v[108:111], v[176:179], v[24:27]
    ds_read_b64_tr_b16 v[138:139], v198 offset:15616
    ds_read_b64_tr_b16 v[140:141], v199 offset:12544
    v_mfma_f32_16x16x32_bf16 v[28:31], v[108:111], v[180:183], v[28:31]
    ds_read_b64_tr_b16 v[142:143], v199 offset:15616
    v_mfma_f32_16x16x32_bf16 v[32:35], v[112:115], v[176:179], v[32:35]
    s_add_u32 s43, s48, 5
    s_cmp_ge_u32 s43, s53
    s_cselect_b32 s45, 0x70000000, s45
    s_cselect_b32 s46, 0x70000000, s46
    s_add_u32 m0, s47, 36864
    s_nop 0
    buffer_load_dwordx4 v200, s[20:23], s45 offen lds
    v_mfma_f32_16x16x32_bf16 v[36:39], v[112:115], v[180:183], v[36:39]
    s_add_u32 m0, s47, 37888
    s_nop 0
    buffer_load_dwordx4 v201, s[20:23], s45 offen lds
    v_mfma_f32_16x16x32_bf16 v[40:43], v[116:119], v[176:179], v[40:43]
    s_add_u32 m0, s47, 38912
    s_nop 0
    buffer_load_dwordx4 v202, s[20:23], s45 offen lds
    s_add_u32 s45, s45, 36864
    v_mfma_f32_16x16x32_bf16 v[44:47], v[116:119], v[180:183], v[44:47]
    s_waitcnt lgkmcnt(0)
    v_mfma_f32_16x16x32_bf16 v[48:51], v[120:123], v[176:179], v[48:51]
    ds_read_b64_tr_b16 v[96:97], v196 offset:24576
    ds_read_b64_tr_b16 v[98:99], v196 offset:27648
    v_mfma_f32_16x16x32_bf16 v[52:55], v[120:123], v[180:183], v[52:55]
    ds_read_b64_tr_b16 v[100:101], v197 offset:24576
    v_mfma_f32_16x16x32_bf16 v[56:59], v[124:127], v[176:179], v[56:59]
    ds_read_b64_tr_b16 v[102:103], v197 offset:27648
    ds_read_b64_tr_b16 v[104:105], v198 offset:24576
    v_mfma_f32_16x16x32_bf16 v[60:63], v[124:127], v[180:183], v[60:63]
    ds_read_b64_tr_b16 v[106:107], v198 offset:27648
    v_mfma_f32_16x16x32_bf16 v[64:67], v[128:131], v[176:179], v[64:67]
    ds_read_b64_tr_b16 v[108:109], v199 offset:24576
    ds_read_b64_tr_b16 v[110:111], v199 offset:27648
    v_mfma_f32_16x16x32_bf16 v[68:71], v[128:131], v[180:183], v[68:71]
    ds_read_b64_tr_b16 v[112:113], v196 offset:24704
    v_mfma_f32_16x16x32_bf16 v[72:75], v[132:135], v[176:179], v[72:75]
    ds_read_b64_tr_b16 v[114:115], v196 offset:27776
    ds_read_b64_tr_b16 v[116:117], v197 offset:24704
    v_mfma_f32_16x16x32_bf16 v[76:79], v[132:135], v[180:183], v[76:79]
    ds_read_b64_tr_b16 v[118:119], v197 offset:27776
    v_mfma_f32_16x16x32_bf16 v[80:83], v[136:139], v[176:179], v[80:83]
    buffer_load_dwordx4 v[168:171], v203, s[24:27], s46 offen
    v_mfma_f32_16x16x32_bf16 v[84:87], v[136:139], v[180:183], v[84:87]
    buffer_load_dwordx4 v[172:175], v203, s[24:27], s46 offen offset:256
    s_add_u32 s46, s46, 2048
    v_mfma_f32_16x16x32_bf16 v[88:91], v[140:143], v[176:179], v[88:91]
    v_mfma_f32_16x16x32_bf16 v[92:95], v[140:143], v[180:183], v[92:95]
    s_add_u32 s48, s48, 1
    s_cmp_ge_u32 s48, s53
    s_cbranch_scc1 K2B_DONE
    s_waitcnt lgkmcnt(0)
    s_waitcnt vmcnt(15)
    s_barrier
    v_mfma_f32_16x16x32_bf16 v[0:3], v[96:99], v[184:187], v[0:3]
    ds_read_b64_tr_b16 v[120:121], v198 offset:24704
    ds_read_b64_tr_b16 v[122:123], v198 offset:27776
    v_mfma_f32_16x16x32_bf16 v[4:7], v[96:99], v[188:191], v[4:7]
    ds_read_b64_tr_b16 v[124:125], v199 offset:24704
    v_mfma_f32_16x16x32_bf16 v[8:11], v[100:103], v[184:187], v[8:11]
    ds_read_b64_tr_b16 v[126:127], v199 offset:27776
    ds_read_b64_tr_b16 v[128:129], v196 offset:24832
    v_mfma_f32_16x16x32_bf16 v[12:15], v[100:103], v[188:191], v[12:15]
    ds_read_b64_tr_b16 v[130:131], v196 offset:27904
    v_mfma_f32_16x16x32_bf16 v[16:19], v[104:107], v[184:187], v[16:19]
    ds_read_b64_tr_b16 v[132:133], v197 offset:24832
    ds_read_b64_tr_b16 v[134:135], v197 offset:27904
    v_mfma_f32_16x16x32_bf16 v[20:23], v[104:107], v[188:191], v[20:23]
    ds_read_b64_tr_b16 v[136:137], v198 offset:24832
    v_mfma_f32_16x16x32_bf16 v[24:27], v[108:111], v[184:187], v[24:27]
    ds_read_b64_tr_b16 v[138:139], v198 offset:27904
    ds_read_b64_tr_b16 v[140:141], v199 offset:24832
    v_mfma_f32_16x16x32_bf16 v[28:31], v[108:111], v[188:191], v[28:31]
    ds_read_b64_tr_b16 v[142:143], v199 offset:27904
    v_mfma_f32_16x16x32_bf16 v[32:35], v[112:115], v[184:187], v[32:35]
    s_add_u32 s43, s48, 5
    s_cmp_ge_u32 s43, s53
    s_cselect_b32 s45, 0x70000000, s45
    s_cselect_b32 s46, 0x70000000, s46
    s_add_u32 m0, s47, 49152
    s_nop 0
    buffer_load_dwordx4 v200, s[20:23], s45 offen lds
    v_mfma_f32_16x16x32_bf16 v[36:39], v[112:115], v[188:191], v[36:39]
    s_add_u32 m0, s47, 50176
    s_nop 0
    buffer_load_dwordx4 v201, s[20:23], s45 offen lds
    v_mfma_f32_16x16x32_bf16 v[40:43], v[116:119], v[184:187], v[40:43]
    s_add_u32 m0, s47, 51200
    s_nop 0
    buffer_load_dwordx4 v202, s[20:23], s45 offen lds
    s_add_u32 s45, s45, 36864
    v_mfma_f32_16x16x32_bf16 v[44:47], v[116:119], v[188:191], v[44:47]
    s_waitcnt lgkmcnt(0)
    v_mfma_f32_16x16x32_bf16 v[48:51], v[120:123], v[184:187], v[48:51]
    ds_read_b64_tr_b16 v[96:97], v192 offset:0
    ds_read_b64_tr_b16 v[98:99], v192 offset:3072
    v_mfma_f32_16x16x32_bf16 v[52:55], v[120:123], v[188:191], v[52:55]
    ds_read_b64_tr_b16 v[100:101], v193 offset:0
    v_mfma_f32_16x16x32_bf16 v[56:59], v[124:127], v[184:187], v[56:59]
    ds_read_b64_tr_b16 v[102:103], v193 offset:3072
    ds_read_b64_tr_b16 v[104:105], v194 offset:0
    v_mfma_f32_16x16x32_bf16 v[60:63], v[124:127], v[188:191], v[60:63]
    ds_read_b64_tr_b16 v[106:107], v194 offset:3072
    v_mfma_f32_16x16x32_bf16 v[64:67], v[128:131], v[184:187], v[64:67]
    ds_read_b64_tr_b16 v[108:109], v195 offset:0
    ds_read_b64_tr_b16 v[110:111], v195 offset:3072
    v_mfma_f32_16x16x32_bf16 v[68:71], v[128:131], v[188:191], v[68:71]
    ds_read_b64_tr_b16 v[112:113], v192 offset:128
    v_mfma_f32_16x16x32_bf16 v[72:75], v[132:135], v[184:187], v[72:75]
    ds_read_b64_tr_b16 v[114:115], v192 offset:3200
    ds_read_b64_tr_b16 v[116:117], v193 offset:128
    v_mfma_f32_16x16x32_bf16 v[76:79], v[132:135], v[188:191], v[76:79]
    ds_read_b64_tr_b16 v[118:119], v193 offset:3200
    v_mfma_f32_16x16x32_bf16 v[80:83], v[136:139], v[184:187], v[80:83]
    buffer_load_dwordx4 v[176:179], v203, s[24:27], s46 offen
    v_mfma_f32_16x16x32_bf16 v[84:87], v[136:139], v[188:191], v[84:87]
    buffer_load_dwordx4 v[180:183], v203, s[24:27], s46 offen offset:256
    s_add_u32 s46, s46, 2048
    v_mfma_f32_16x16x32_bf16 v[88:91], v[140:143], v[184:187], v[88:91]
    v_mfma_f32_16x16x32_bf16 v[92:95], v[140:143], v[188:191], v[92:95]
    s_add_u32 s48, s48, 1
    s_cmp_ge_u32 s48, s53
    s_cbranch_scc1 K2B_DONE
    s_cmp_lg_u32 s48, 24
    s_cbranch_scc1 K2B_LOOP
    s_mov_b32 exec_hi, 0xfff
    buffer_load_dword v214, v215, s[32:35], s56 offen
    s_mov_b64 exec, -1
    s_branch K2B_LOOP
K2B_DONE:
    s_setprio 3
    s_lshl_b32 s43, s49, 6
    s_add_u32 s43, s43, s52
    s_mul_i32 s43, s43, 18
    s_mul_i32 s44, s50, 6
    s_add_u32 s43, s43, s44
    s_lshl_b32 s54, s43, 11
    s_add_u32 s54, s54, 24117248
    s_waitcnt lgkmcnt(0)
    s_nop 7
    v_cvt_pk_bf16_f32 v96, v0, v1
    v_cvt_pk_bf16_f32 v97, v2, v3
    v_cvt_pk_bf16_f32 v98, v4, v5
    v_cvt_pk_bf16_f32 v99, v6, v7
    v_cvt_pk_bf16_f32 v100, v8, v9
    v_cvt_pk_bf16_f32 v101, v10, v11
    v_cvt_pk_bf16_f32 v102, v12, v13
    v_cvt_pk_bf16_f32 v103, v14, v15
    v_permlane32_swap_b32 v96, v98
    v_permlane32_swap_b32 v97, v99
    buffer_store_dwordx4 v[96:99], v204, s[24:27], s54 offen offset:0 sc1
    v_cvt_pk_bf16_f32 v104, v16, v17
    v_cvt_pk_bf16_f32 v105, v18, v19
    v_cvt_pk_bf16_f32 v106, v20, v21
    v_cvt_pk_bf16_f32 v107, v22, v23
    v_permlane32_swap_b32 v100, v102
    v_permlane32_swap_b32 v101, v103
    buffer_store_dwordx4 v[100:103], v204, s[24:27], s54 offen offset:1024 sc1
    v_cvt_pk_bf16_f32 v108, v24, v25
    v_cvt_pk_bf16_f32 v109, v26, v27
    v_cvt_pk_bf16_f32 v110, v28, v29
    v_cvt_pk_bf16_f32 v111, v30, v31
    v_permlane32_swap_b32 v104, v106
    v_permlane32_swap_b32 v105, v107
    buffer_store_dwordx4 v[104:107], v204, s[24:27], s54 offen offset:2048 sc1
    v_cvt_pk_bf16_f32 v112, v32, v33
    v_cvt_pk_bf16_f32 v113, v34, v35
    v_cvt_pk_bf16_f32 v114, v36, v37
    v_cvt_pk_bf16_f32 v115, v38, v39
    v_permlane32_swap_b32 v108, v110
    v_permlane32_swap_b32 v109, v111
    buffer_store_dwordx4 v[108:111], v204, s[24:27], s54 offen offset:3072 sc1
    v_cvt_pk_bf16_f32 v116, v40, v41
    v_cvt_pk_bf16_f32 v117, v42, v43
    v_cvt_pk_bf16_f32 v118, v44, v45
    v_cvt_pk_bf16_f32 v119, v46, v47
    v_permlane32_swap_b32 v112, v114
    v_permlane32_swap_b32 v113, v115
    s_add_u32 s54, s54, 4096
    buffer_store_dwordx4 v[112:115], v204, s[24:27], s54 offen offset:0 sc1
    v_cvt_pk_bf16_f32 v120, v48, v49
    v_cvt_pk_bf16_f32 v121, v50, v51
    v_cvt_pk_bf16_f32 v122, v52, v53
    v_cvt_pk_bf16_f32 v123, v54, v55
    v_permlane32_swap_b32 v116, v118
    v_permlane32_swap_b32 v117, v119
    buffer_store_dwordx4 v[116:119], v204, s[24:27], s54 offen offset:1024 sc1
    v_cvt_pk_bf16_f32 v124, v56, v57
    v_cvt_pk_bf16_f32 v125, v58, v59
    v_cvt_pk_bf16_f32 v126, v60, v61
    v_cvt_pk_bf16_f32 v127, v62, v63
    v_permlane32_swap_b32 v120, v122
    v_permlane32_swap_b32 v121, v123
    buffer_store_dwordx4 v[120:123], v204, s[24:27], s54 offen offset:2048 sc1
    v_cvt_pk_bf16_f32 v128, v64, v65
    v_cvt_pk_bf16_f32 v129, v66, v67
    v_cvt_pk_bf16_f32 v130, v68, v69
    v_cvt_pk_bf16_f32 v131, v70, v71
    v_permlane32_swap_b32 v124, v126
    v_permlane32_swap_b32 v125, v127
    buffer_store_dwordx4 v[124:127], v204, s[24:27], s54 offen offset:3072 sc1
    v_cvt_pk_bf16_f32 v132, v72, v73
    v_cvt_pk_bf16_f32 v133, v74, v75
    v_cvt_pk_bf16_f32 v134, v76, v77
    v_cvt_pk_bf16_f32 v135, v78, v79
    v_permlane32_swap_b32 v128, v130
    v_permlane32_swap_b32 v129, v131
    s_add_u32 s54, s54, 4096
    buffer_store_dwordx4 v[128:131], v204, s[24:27], s54 offen offset:0 sc1
    v_cvt_pk_bf16_f32 v136, v80, v81
    v_cvt_pk_bf16_f32 v137, v82, v83
    v_cvt_pk_bf16_f32 v138, v84, v85
    v_cvt_pk_bf16_f32 v139, v86, v87
    v_permlane32_swap_b32 v132, v134
    v_permlane32_swap_b32 v133, v135
    buffer_store_dwordx4 v[132:135], v204, s[24:27], s54 offen offset:1024 sc1
    v_cvt_pk_bf16_f32 v140, v88, v89
    v_cvt_pk_bf16_f32 v141, v90, v91
    v_cvt_pk_bf16_f32 v142, v92, v93
    v_cvt_pk_bf16_f32 v143, v94, v95
    v_permlane32_swap_b32 v136, v138
    v_permlane32_swap_b32 v137, v139
    buffer_store_dwordx4 v[136:139], v204, s[24:27], s54 offen offset:2048 sc1
    s_nop 1
    v_permlane32_swap_b32 v140, v142
    v_permlane32_swap_b32 v141, v143
    buffer_store_dwordx4 v[140:143], v204, s[24:27], s54 offen offset:3072 sc1
    s_branch K2B_ST
K2B_IDLE:
    s_waitcnt lgkmcnt(0)
K2B_ST:
K2_EXIT:
    s_endpgm
K2A_SLOW:
    s_waitcnt vmcnt(0) lgkmcnt(0)
    v_mov_b32 v89, 0
    v_mov_b32 v140, 0xff800000
    v_mov_b64 v[32:33], 0
    v_mov_b64 v[34:35], 0
    v_mov_b64 v[36:37], 0
    v_mov_b64 v[38:39], 0
    v_mov_b64 v[40:41], 0
    v_mov_b64 v[42:43], 0
    v_mov_b64 v[44:45], 0
    v_mov_b64 v[46:47], 0
    v_mov_b32 v93, 0
    v_mov_b32 v141, 0xff800000
    v_mov_b64 v[48:49], 0
    v_mov_b64 v[50:51], 0
    v_mov_b64 v[52:53], 0
    v_mov_b64 v[54:55], 0
    v_mov_b64 v[56:57], 0
    v_mov_b64 v[58:59], 0
    v_mov_b64 v[60:61], 0
    v_mov_b64 v[62:63], 0
    s_mov_b32 s42, 0
K2A_SLOOP:
    s_lshr_b32 s43, s42, 3
    s_mul_i32 s43, s43, 20480
    s_and_b32 s44, s42, 7
    s_lshl_b32 s50, s44, 10
    s_add_u32 s50, s50, s43
    buffer_load_dwordx4 v[96:99], v131, s[20:23], s50 offen
    s_lshl_b32 s50, s44, 7
    s_add_u32 s50, s50, s43
    s_add_u32 s50, s50, 18432
    buffer_load_dword v104, v132, s[20:23], s50 offen
    s_mul_i32 s50, s44, 1280
    s_add_u32 s50, s50, s43
    s_add_u32 s50, s50, 8192
    buffer_load_dwordx4 v[112:115], v133, s[20:23], s50 offen offset:0
    buffer_load_dwordx4 v[116:119], v133, s[20:23], s50 offen offset:640
    s_waitcnt vmcnt(0)
    v_mfma_f32_32x32x16_bf16 v[0:15], v[96:99], v[80:83], 0
    v_mfma_f32_32x32x16_bf16 v[0:15], v[104:107], v[88:91], v[0:15]
    v_mfma_f32_32x32x16_bf16 v[16:31], v[96:99], v[84:87], 0
    v_mfma_f32_32x32x16_bf16 v[16:31], v[104:107], v[92:95], v[16:31]
    s_nop 15
    v_max3_f32 v142, v0, v1, v140
    v_max3_f32 v142, v142, v2, v3
    v_max3_f32 v142, v142, v4, v5
    v_max3_f32 v142, v142, v6, v7
    v_max3_f32 v142, v142, v8, v9
    v_max3_f32 v142, v142, v10, v11
    v_max3_f32 v142, v142, v12, v13
    v_max3_f32 v142, v142, v14, v15
    v_mov_b32 v143, v142
    s_nop 1
    v_permlane32_swap_b32 v142, v143
    s_nop 1
    v_max_f32 v142, v142, v143
    v_sub_f32 v143, v140, v142
    v_exp_f32 v143, v143
    v_mov_b32 v140, v142
    v_sub_f32 v0, v0, v142
    v_sub_f32 v1, v1, v142
    v_sub_f32 v2, v2, v142
    v_sub_f32 v3, v3, v142
    v_sub_f32 v4, v4, v142
    v_sub_f32 v5, v5, v142
    v_sub_f32 v6, v6, v142
    v_sub_f32 v7, v7, v142
    v_sub_f32 v8, v8, v142
    v_sub_f32 v9, v9, v142
    v_sub_f32 v10, v10, v142
    v_sub_f32 v11, v11, v142
    v_sub_f32 v12, v12, v142
    v_sub_f32 v13, v13, v142
    v_sub_f32 v14, v14, v142
    v_sub_f32 v15, v15, v142
    v_mul_f32 v32, v32, v143
    v_mul_f32 v33, v33, v143
    v_mul_f32 v34, v34, v143
    v_mul_f32 v35, v35, v143
    v_mul_f32 v36, v36, v143
    v_mul_f32 v37, v37, v143
    v_mul_f32 v38, v38, v143
    v_mul_f32 v39, v39, v143
    v_mul_f32 v40, v40, v143
    v_mul_f32 v41, v41, v143
    v_mul_f32 v42, v42, v143
    v_mul_f32 v43, v43, v143
    v_mul_f32 v44, v44, v143
    v_mul_f32 v45, v45, v143
    v_mul_f32 v46, v46, v143
    v_mul_f32 v47, v47, v143
    v_exp_f32 v0, v0
    v_exp_f32 v1, v1
    v_exp_f32 v2, v2
    v_cvt_pk_bf16_f32 v64, v0, v1
    v_exp_f32 v3, v3
    v_exp_f32 v4, v4
    v_cvt_pk_bf16_f32 v65, v2, v3
    v_exp_f32 v5, v5
    v_exp_f32 v6, v6
    v_cvt_pk_bf16_f32 v66, v4, v5
    v_exp_f32 v7, v7
    v_exp_f32 v8, v8
    v_cvt_pk_bf16_f32 v67, v6, v7
    v_exp_f32 v9, v9
    v_exp_f32 v10, v10
    v_cvt_pk_bf16_f32 v68, v8, v9
    v_exp_f32 v11, v11
    v_exp_f32 v12, v12
    v_cvt_pk_bf16_f32 v69, v10, v11
    v_exp_f32 v13, v13
    v_exp_f32 v14, v14
    v_exp_f32 v15, v15
    v_cvt_pk_bf16_f32 v70, v12, v13
    v_cvt_pk_bf16_f32 v71, v14, v15
    s_nop 1
    v_mfma_f32_32x32x16_bf16 v[32:47], v[112:115], v[64:67], v[32:47]
    v_mfma_f32_32x32x16_bf16 v[32:47], v[116:119], v[68:71], v[32:47]
    v_max3_f32 v142, v16, v17, v141
    v_max3_f32 v142, v142, v18, v19
    v_max3_f32 v142, v142, v20, v21
    v_max3_f32 v142, v142, v22, v23
    v_max3_f32 v142, v142, v24, v25
    v_max3_f32 v142, v142, v26, v27
    v_max3_f32 v142, v142, v28, v29
    v_max3_f32 v142, v142, v30, v31
    v_mov_b32 v143, v142
    s_nop 1
    v_permlane32_swap_b32 v142, v143
    s_nop 1
    v_max_f32 v142, v142, v143
    v_sub_f32 v143, v141, v142
    v_exp_f32 v143, v143
    v_mov_b32 v141, v142
    v_sub_f32 v16, v16, v142
    v_sub_f32 v17, v17, v142
    v_sub_f32 v18, v18, v142
    v_sub_f32 v19, v19, v142
    v_sub_f32 v20, v20, v142
    v_sub_f32 v21, v21, v142
    v_sub_f32 v22, v22, v142
    v_sub_f32 v23, v23, v142
    v_sub_f32 v24, v24, v142
    v_sub_f32 v25, v25, v142
    v_sub_f32 v26, v26, v142
    v_sub_f32 v27, v27, v142
    v_sub_f32 v28, v28, v142
    v_sub_f32 v29, v29, v142
    v_sub_f32 v30, v30, v142
    v_sub_f32 v31, v31, v142
    v_mul_f32 v48, v48, v143
    v_mul_f32 v49, v49, v143
    v_mul_f32 v50, v50, v143
    v_mul_f32 v51, v51, v143
    v_mul_f32 v52, v52, v143
    v_mul_f32 v53, v53, v143
    v_mul_f32 v54, v54, v143
    v_mul_f32 v55, v55, v143
    v_mul_f32 v56, v56, v143
    v_mul_f32 v57, v57, v143
    v_mul_f32 v58, v58, v143
    v_mul_f32 v59, v59, v143
    v_mul_f32 v60, v60, v143
    v_mul_f32 v61, v61, v143
    v_mul_f32 v62, v62, v143
    v_mul_f32 v63, v63, v143
    v_exp_f32 v16, v16
    v_exp_f32 v17, v17
    v_exp_f32 v18, v18
    v_cvt_pk_bf16_f32 v72, v16, v17
    v_exp_f32 v19, v19
    v_exp_f32 v20, v20
    v_cvt_pk_bf16_f32 v73, v18, v19
    v_exp_f32 v21, v21
    v_exp_f32 v22, v22
    v_cvt_pk_bf16_f32 v74, v20, v21
    v_exp_f32 v23, v23
    v_exp_f32 v24, v24
    v_cvt_pk_bf16_f32 v75, v22, v23
    v_exp_f32 v25, v25
    v_exp_f32 v26, v26
    v_cvt_pk_bf16_f32 v76, v24, v25
    v_exp_f32 v27, v27
    v_exp_f32 v28, v28
    v_cvt_pk_bf16_f32 v77, v26, v27
    v_exp_f32 v29, v29
    v_exp_f32 v30, v30
    v_exp_f32 v31, v31
    v_cvt_pk_bf16_f32 v78, v28, v29
    v_cvt_pk_bf16_f32 v79, v30, v31
    s_nop 1
    v_mfma_f32_32x32x16_bf16 v[48:63], v[112:115], v[72:75], v[48:63]
    v_mfma_f32_32x32x16_bf16 v[48:63], v[116:119], v[76:79], v[48:63]
    s_nop 15
    s_add_u32 s42, s42, 1
    s_cmp_lt_u32 s42, 64
    s_cbranch_scc1 K2A_SLOOP
    s_branch K2A_FIN
.globl k3_kernel
.p2align 8
.type k3_kernel,@function
k3_kernel:
    s_cmp_ge_u32 s2, 248
    s_cbranch_scc1 K3_EXIT
    s_load_dwordx2 s[12:13], s[0:1], 32
    s_load_dwordx2 s[16:17], s[0:1], 88
    s_load_dwordx2 s[14:15], s[0:1], 72
    v_and_b32 v201, 63, v0
    v_lshrrev_b32 v204, 6, v0
    s_and_b32 s43, s2, 7
    s_cmp_eq_u32 s43, 7
    s_cselect_b32 s46, 31, 29
    s_mul_i32 s43, s43, 29
    v_readfirstlane_b32 s40, v204
    s_lshr_b32 s44, s2, 3
    s_add_u32 s43, s43, s44
    s_cmp_ge_u32 s44, s46
    s_cbranch_scc1 K3_EXIT
    s_mul_i32 s46, s43, 7282
    s_lshr_b32 s46, s46, 16
    s_mul_i32 s44, s46, 9
    s_sub_u32 s45, s43, s44
    v_lshrrev_b32 v204, 3, v201
    v_and_b32 v205, 7, v201
    v_and_b32 v206, 6, v204
    v_xor_b32 v205, v205, v206
    v_mul_u32_u24 v204, 1152, v204
    v_lshl_add_u32 v200, v205, 4, v204
    s_mul_i32 s41, s46, 5
    s_add_u32 s41, s41, s40
    v_and_b32 v205, 15, v201
    v_bfe_u32 v206, v201, 4, 1
    v_lshl_add_u32 v206, v206, 5, v205
    v_lshlrev_b32 v206, 4, v206
    v_lshrrev_b32 v207, 5, v201
    v_lshl_add_u32 v202, v207, 10, v206
    s_mul_i32 s50, s40, 15
    s_min_u32 s50, s50, 57
    s_lshl_b32 s51, s50, 10
    s_mul_i32 s50, s50, 9216
    s_lshl_b32 s43, s45, 7
    s_add_u32 s50, s50, s43
    s_lshr_b32 s43, s41, 1
    s_and_b32 s44, s41, 1
    s_lshl_b32 s44, s44, 8
    s_mul_i32 s52, s43, 36864
    s_add_u32 s52, s52, s44
    s_add_u32 s52, s52, 21495808
    s_mul_i32 s53, s43, 18
    s_lshl_b32 s54, s45, 1
    s_add_u32 s53, s53, s54
    s_lshl_b32 s53, s53, 11
    s_add_u32 s53, s53, s44
    s_add_u32 s53, s53, 24117248
    s_cmp_ge_u32 s41, 128
    s_cselect_b32 s52, 0x70000000, s52
    s_cselect_b32 s53, 0x70000000, s53
    s_waitcnt lgkmcnt(0)
    s_mov_b32 s20, s12
    s_and_b32 s21, s13, 0xffff
    s_mov_b32 s22, 0xa2000
    s_mov_b32 s23, 0x00020000
    s_mov_b32 s24, s16
    s_and_b32 s25, s17, 0xffff
    s_mov_b32 s26, 0x10000000
    s_mov_b32 s27, 0x00020000
    s_add_u32 m0, s51, 0
    s_add_u32 s43, s50, 0
    buffer_load_dwordx4 v200, s[20:23], s43 offen lds
    s_add_u32 m0, s51, 1024
    s_add_u32 s43, s50, 9216
    buffer_load_dwordx4 v200, s[20:23], s43 offen lds
    s_add_u32 m0, s51, 2048
    s_add_u32 s43, s50, 18432
    buffer_load_dwordx4 v200, s[20:23], s43 offen lds
    s_add_u32 m0, s51, 3072
    s_add_u32 s43, s50, 27648
    buffer_load_dwordx4 v200, s[20:23], s43 offen lds
    s_add_u32 m0, s51, 4096
    s_add_u32 s43, s50, 36864
    buffer_load_dwordx4 v200, s[20:23], s43 offen lds
    s_add_u32 m0, s51, 5120
    s_add_u32 s43, s50, 46080
    buffer_load_dwordx4 v200, s[20:23], s43 offen lds
    s_add_u32 m0, s51, 6144
    s_add_u32 s43, s50, 55296
    buffer_load_dwordx4 v200, s[20:23], s43 offen lds
    s_add_u32 m0, s51, 7168
    s_add_u32 s43, s50, 64512
    buffer_load_dwordx4 v200, s[20:23], s43 offen lds
    s_add_u32 m0, s51, 8192
    s_add_u32 s43, s50, 73728
    buffer_load_dwordx4 v200, s[20:23], s43 offen lds
    s_add_u32 m0, s51, 9216
    s_add_u32 s43, s50, 82944
    buffer_load_dwordx4 v200, s[20:23], s43 offen lds
    s_add_u32 m0, s51, 10240
    s_add_u32 s43, s50, 92160
    buffer_load_dwordx4 v200, s[20:23], s43 offen lds
    s_add_u32 m0, s51, 11264
    s_add_u32 s43, s50, 101376
    buffer_load_dwordx4 v200, s[20:23], s43 offen lds
    s_add_u32 m0, s51, 12288
    s_add_u32 s43, s50, 110592
    buffer_load_dwordx4 v200, s[20:23], s43 offen lds
    s_add_u32 m0, s51, 13312
    s_add_u32 s43, s50, 119808
    buffer_load_dwordx4 v200, s[20:23], s43 offen lds
    s_add_u32 m0, s51, 14336
    s_add_u32 s43, s50, 129024
    buffer_load_dwordx4 v200, s[20:23], s43 offen lds
    buffer_load_dwordx4 v[16:19], v202, s[24:27], s52 offen offset:0
    buffer_load_dwordx4 v[20:23], v202, s[24:27], s52 offen offset:2048
    s_add_u32 s52, s52, 4096
    buffer_load_dwordx4 v[24:27], v202, s[24:27], s52 offen offset:0
    buffer_load_dwordx4 v[28:31], v202, s[24:27], s52 offen offset:2048
    s_add_u32 s52, s52, 4096
    buffer_load_dwordx4 v[32:35], v202, s[24:27], s52 offen offset:0
    buffer_load_dwordx4 v[36:39], v202, s[24:27], s52 offen offset:2048
    s_add_u32 s52, s52, 4096
    buffer_load_dwordx4 v[40:43], v202, s[24:27], s52 offen offset:0
    buffer_load_dwordx4 v[44:47], v202, s[24:27], s52 offen offset:2048
    s_add_u32 s52, s52, 4096
    buffer_load_dwordx4 v[48:51], v202, s[24:27], s52 offen offset:0
    buffer_load_dwordx4 v[52:55], v202, s[24:27], s52 offen offset:2048
    s_add_u32 s52, s52, 4096
    buffer_load_dwordx4 v[56:59], v202, s[24:27], s52 offen offset:0
    buffer_load_dwordx4 v[60:63], v202, s[24:27], s52 offen offset:2048
    s_mov_b32 s32, s14
    s_and_b32 s33, s15, 0xffff
    s_mov_b32 s34, 0x240000
    s_mov_b32 s35, 0x00020000
    v_mul_u32_u24 v203, 1152, v205
    v_and_b32 v206, 48, v201
    v_add_u32 v203, v203, v206
    s_mul_i32 s54, s41, 18432
    s_lshl_b32 s43, s45, 7
    s_add_u32 s54, s54, s43
    v_and_b32 v192, 3, v201
    v_lshlrev_b32 v192, 3, v192
    v_bfe_u32 v204, v201, 2, 3
    v_mul_u32_u24 v206, 18, v207
    v_add_u32 v204, v204, v206
    v_bfe_u32 v193, v201, 3, 1
    v_bfe_u32 v194, v201, 4, 2
    v_lshl_add_u32 v193, v194, 2, v193
    v_mul_u32_u24 v193, 18, v193
    v_bfe_u32 v194, v201, 2, 1
    v_add3_u32 v193, v193, v194, 16
    v_bfe_u32 v195, v204, 1, 2
    v_lshl_add_u32 v196, v204, 7, v192
    v_xor_b32 v197, 0, v195
    v_lshl_add_u32 v160, v197, 5, v196
    v_xor_b32 v197, 1, v195
    v_lshl_add_u32 v161, v197, 5, v196
    v_xor_b32 v197, 2, v195
    v_lshl_add_u32 v162, v197, 5, v196
    v_xor_b32 v197, 3, v195
    v_lshl_add_u32 v163, v197, 5, v196
    v_add_u32 v204, 36, v204
    v_bfe_u32 v195, v204, 1, 2
    v_lshl_add_u32 v196, v204, 7, v192
    v_xor_b32 v197, 0, v195
    v_lshl_add_u32 v164, v197, 5, v196
    v_xor_b32 v197, 1, v195
    v_lshl_add_u32 v165, v197, 5, v196
    v_xor_b32 v197, 2, v195
    v_lshl_add_u32 v166, v197, 5, v196
    v_xor_b32 v197, 3, v195
    v_lshl_add_u32 v167, v197, 5, v196
    v_bfe_u32 v195, v193, 1, 2
    v_lshl_add_u32 v196, v193, 7, v192
    v_xor_b32 v197, 0, v195
    v_lshl_add_u32 v168, v197, 5, v196
    v_xor_b32 v197, 1, v195
    v_lshl_add_u32 v169, v197, 5, v196
    v_xor_b32 v197, 2, v195
    v_lshl_add_u32 v170, v197, 5, v196
    v_xor_b32 v197, 3, v195
    v_lshl_add_u32 v171, v197, 5, v196
    v_add_u32 v193, 36, v193
    v_bfe_u32 v195, v193, 1, 2
    v_lshl_add_u32 v196, v193, 7, v192
    v_xor_b32 v197, 0, v195
    v_lshl_add_u32 v172, v197, 5, v196
    v_xor_b32 v197, 1, v195
    v_lshl_add_u32 v173, v197, 5, v196
    v_xor_b32 v197, 2, v195
    v_lshl_add_u32 v174, v197, 5, v196
    v_xor_b32 v197, 3, v195
    v_lshl_add_u32 v175, v197, 5, v196
    s_waitcnt vmcnt(12)
    s_barrier
    ds_read_b64_tr_b16 v[128:129], v160 offset:0
    ds_read_b64_tr_b16 v[130:131], v160 offset:1024
    ds_read_b64_tr_b16 v[132:133], v161 offset:0
    ds_read_b64_tr_b16 v[134:135], v161 offset:1024
    ds_read_b64_tr_b16 v[136:137], v162 offset:0
    ds_read_b64_tr_b16 v[138:139], v162 offset:1024
    ds_read_b64_tr_b16 v[140:141], v163 offset:0
    ds_read_b64_tr_b16 v[142:143], v163 offset:1024
    s_add_u32 s52, s52, 4096
    buffer_load_dwordx4 v[64:67], v202, s[24:27], s52 offen offset:0
    buffer_load_dwordx4 v[68:71], v202, s[24:27], s52 offen offset:2048
    ds_read_b64_tr_b16 v[144:145], v164 offset:0
    ds_read_b64_tr_b16 v[146:147], v164 offset:1024
    ds_read_b64_tr_b16 v[148:149], v165 offset:0
    ds_read_b64_tr_b16 v[150:151], v165 offset:1024
    ds_read_b64_tr_b16 v[152:153], v166 offset:0
    ds_read_b64_tr_b16 v[154:155], v166 offset:1024
    ds_read_b64_tr_b16 v[156:157], v167 offset:0
    ds_read_b64_tr_b16 v[158:159], v167 offset:1024
    s_waitcnt vmcnt(13) lgkmcnt(8)
    v_mfma_f32_16x16x32_bf16 v[0:3], v[128:131], v[16:19], 0
    v_mfma_f32_16x16x32_bf16 v[4:7], v[132:135], v[16:19], 0
    v_mfma_f32_16x16x32_bf16 v[8:11], v[136:139], v[16:19], 0
    v_mfma_f32_16x16x32_bf16 v[12:15], v[140:143], v[16:19], 0
    s_add_u32 s52, s52, 4096
    buffer_load_dwordx4 v[72:75], v202, s[24:27], s52 offen offset:0
    buffer_load_dwordx4 v[76:79], v202, s[24:27], s52 offen offset:2048
    ds_read_b64_tr_b16 v[128:129], v160 offset:9216
    ds_read_b64_tr_b16 v[130:131], v160 offset:10240
    ds_read_b64_tr_b16 v[132:133], v161 offset:9216
    ds_read_b64_tr_b16 v[134:135], v161 offset:10240
    ds_read_b64_tr_b16 v[136:137], v162 offset:9216
    ds_read_b64_tr_b16 v[138:139], v162 offset:10240
    ds_read_b64_tr_b16 v[140:141], v163 offset:9216
    ds_read_b64_tr_b16 v[142:143], v163 offset:10240
    s_waitcnt vmcnt(14) lgkmcnt(8)
    v_mfma_f32_16x16x32_bf16 v[0:3], v[144:147], v[20:23], v[0:3]
    v_mfma_f32_16x16x32_bf16 v[4:7], v[148:151], v[20:23], v[4:7]
    v_mfma_f32_16x16x32_bf16 v[8:11], v[152:155], v[20:23], v[8:11]
    v_mfma_f32_16x16x32_bf16 v[12:15], v[156:159], v[20:23], v[12:15]
    s_add_u32 s52, s52, 4096
    buffer_load_dwordx4 v[80:83], v202, s[24:27], s52 offen offset:0
    buffer_load_dwordx4 v[84:87], v202, s[24:27], s52 offen offset:2048
    ds_read_b64_tr_b16 v[144:145], v164 offset:9216
    ds_read_b64_tr_b16 v[146:147], v164 offset:10240
    ds_read_b64_tr_b16 v[148:149], v165 offset:9216
    ds_read_b64_tr_b16 v[150:151], v165 offset:10240
    ds_read_b64_tr_b16 v[152:153], v166 offset:9216
    ds_read_b64_tr_b16 v[154:155], v166 offset:10240
    ds_read_b64_tr_b16 v[156:157], v167 offset:9216
    ds_read_b64_tr_b16 v[158:159], v167 offset:10240
    s_waitcnt vmcnt(15) lgkmcnt(8)
    v_mfma_f32_16x16x32_bf16 v[0:3], v[128:131], v[24:27], v[0:3]
    v_mfma_f32_16x16x32_bf16 v[4:7], v[132:135], v[24:27], v[4:7]
    v_mfma_f32_16x16x32_bf16 v[8:11], v[136:139], v[24:27], v[8:11]
    v_mfma_f32_16x16x32_bf16 v[12:15], v[140:143], v[24:27], v[12:15]
    buffer_load_dwordx4 v[88:91], v202, s[24:27], s53 offen offset:0
    buffer_load_dwordx4 v[92:95], v202, s[24:27], s53 offen offset:2048
    ds_read_b64_tr_b16 v[128:129], v160 offset:18432
    ds_read_b64_tr_b16 v[130:131], v160 offset:19456
    ds_read_b64_tr_b16 v[132:133], v161 offset:18432
    ds_read_b64_tr_b16 v[134:135], v161 offset:19456
    ds_read_b64_tr_b16 v[136:137], v162 offset:18432
    ds_read_b64_tr_b16 v[138:139], v162 offset:19456
    ds_read_b64_tr_b16 v[140:141], v163 offset:18432
    ds_read_b64_tr_b16 v[142:143], v163 offset:19456
    s_waitcnt vmcnt(16) lgkmcnt(8)
    v_mfma_f32_16x16x32_bf16 v[0:3], v[144:147], v[28:31], v[0:3]
    v_mfma_f32_16x16x32_bf16 v[4:7], v[148:151], v[28:31], v[4:7]
    v_mfma_f32_16x16x32_bf16 v[8:11], v[152:155], v[28:31], v[8:11]
    v_mfma_f32_16x16x32_bf16 v[12:15], v[156:159], v[28:31], v[12:15]
    s_add_u32 s53, s53, 2359296
    buffer_load_dwordx4 v[96:99], v202, s[24:27], s53 offen offset:0
    buffer_load_dwordx4 v[100:103], v202, s[24:27], s53 offen offset:2048
    ds_read_b64_tr_b16 v[144:145], v164 offset:18432
    ds_read_b64_tr_b16 v[146:147], v164 offset:19456
    ds_read_b64_tr_b16 v[148:149], v165 offset:18432
    ds_read_b64_tr_b16 v[150:151], v165 offset:19456
    ds_read_b64_tr_b16 v[152:153], v166 offset:18432
    ds_read_b64_tr_b16 v[154:155], v166 offset:19456
    ds_read_b64_tr_b16 v[156:157], v167 offset:18432
    ds_read_b64_tr_b16 v[158:159], v167 offset:19456
    s_waitcnt vmcnt(17) lgkmcnt(8)
    v_mfma_f32_16x16x32_bf16 v[0:3], v[128:131], v[32:35], v[0:3]
    v_mfma_f32_16x16x32_bf16 v[4:7], v[132:135], v[32:35], v[4:7]
    v_mfma_f32_16x16x32_bf16 v[8:11], v[136:139], v[32:35], v[8:11]
    v_mfma_f32_16x16x32_bf16 v[12:15], v[140:143], v[32:35], v[12:15]
    s_add_u32 s53, s53, 2359296
    buffer_load_dwordx4 v[104:107], v202, s[24:27], s53 offen offset:0
    buffer_load_dwordx4 v[108:111], v202, s[24:27], s53 offen offset:2048
    ds_read_b64_tr_b16 v[128:129], v160 offset:27648
    ds_read_b64_tr_b16 v[130:131], v160 offset:28672
    ds_read_b64_tr_b16 v[132:133], v161 offset:27648
    ds_read_b64_tr_b16 v[134:135], v161 offset:28672
    ds_read_b64_tr_b16 v[136:137], v162 offset:27648
    ds_read_b64_tr_b16 v[138:139], v162 offset:28672
    ds_read_b64_tr_b16 v[140:141], v163 offset:27648
    ds_read_b64_tr_b16 v[142:143], v163 offset:28672
    s_waitcnt vmcnt(18) lgkmcnt(8)
    v_mfma_f32_16x16x32_bf16 v[0:3], v[144:147], v[36:39], v[0:3]
    v_mfma_f32_16x16x32_bf16 v[4:7], v[148:151], v[36:39], v[4:7]
    v_mfma_f32_16x16x32_bf16 v[8:11], v[152:155], v[36:39], v[8:11]
    v_mfma_f32_16x16x32_bf16 v[12:15], v[156:159], v[36:39], v[12:15]
    s_add_u32 s53, s53, 2359296
    buffer_load_dwordx4 v[112:115], v202, s[24:27], s53 offen offset:0
    buffer_load_dwordx4 v[116:119], v202, s[24:27], s53 offen offset:2048
    ds_read_b64_tr_b16 v[144:145], v164 offset:27648
    ds_read_b64_tr_b16 v[146:147], v164 offset:28672
    ds_read_b64_tr_b16 v[148:149], v165 offset:27648
    ds_read_b64_tr_b16 v[150:151], v165 offset:28672
    ds_read_b64_tr_b16 v[152:153], v166 offset:27648
    ds_read_b64_tr_b16 v[154:155], v166 offset:28672
    ds_read_b64_tr_b16 v[156:157], v167 offset:27648
    ds_read_b64_tr_b16 v[158:159], v167 offset:28672
    s_waitcnt vmcnt(19) lgkmcnt(8)
    v_mfma_f32_16x16x32_bf16 v[0:3], v[128:131], v[40:43], v[0:3]
    v_mfma_f32_16x16x32_bf16 v[4:7], v[132:135], v[40:43], v[4:7]
    v_mfma_f32_16x16x32_bf16 v[8:11], v[136:139], v[40:43], v[8:11]
    v_mfma_f32_16x16x32_bf16 v[12:15], v[140:143], v[40:43], v[12:15]
    s_add_u32 s53, s53, 2359296
    buffer_load_dwordx4 v[120:123], v202, s[24:27], s53 offen offset:0
    buffer_load_dwordx4 v[124:127], v202, s[24:27], s53 offen offset:2048
    v_add_u32 v160, 36864, v160
    v_add_u32 v161, 36864, v161
    v_add_u32 v162, 36864, v162
    v_add_u32 v163, 36864, v163
    v_add_u32 v164, 36864, v164
    v_add_u32 v165, 36864, v165
    v_add_u32 v166, 36864, v166
    v_add_u32 v167, 36864, v167
    ds_read_b64_tr_b16 v[128:129], v160 offset:0
    ds_read_b64_tr_b16 v[130:131], v160 offset:1024
    ds_read_b64_tr_b16 v[132:133], v161 offset:0
    ds_read_b64_tr_b16 v[134:135], v161 offset:1024
    ds_read_b64_tr_b16 v[136:137], v162 offset:0
    ds_read_b64_tr_b16 v[138:139], v162 offset:1024
    ds_read_b64_tr_b16 v[140:141], v163 offset:0
    ds_read_b64_tr_b16 v[142:143], v163 offset:1024
    s_waitcnt vmcnt(20) lgkmcnt(8)
    v_mfma_f32_16x16x32_bf16 v[0:3], v[144:147], v[44:47], v[0:3]
    v_mfma_f32_16x16x32_bf16 v[4:7], v[148:151], v[44:47], v[4:7]
    v_mfma_f32_16x16x32_bf16 v[8:11], v[152:155], v[44:47], v[8:11]
    v_mfma_f32_16x16x32_bf16 v[12:15], v[156:159], v[44:47], v[12:15]
    ds_read_b64_tr_b16 v[144:145], v164 offset:0
    ds_read_b64_tr_b16 v[146:147], v164 offset:1024
    ds_read_b64_tr_b16 v[148:149], v165 offset:0
    ds_read_b64_tr_b16 v[150:151], v165 offset:1024
    ds_read_b64_tr_b16 v[152:153], v166 offset:0
    ds_read_b64_tr_b16 v[154:155], v166 offset:1024
    ds_read_b64_tr_b16 v[156:157], v167 offset:0
    ds_read_b64_tr_b16 v[158:159], v167 offset:1024
    s_waitcnt vmcnt(19) lgkmcnt(8)
    v_mfma_f32_16x16x32_bf16 v[0:3], v[128:131], v[48:51], v[0:3]
    v_mfma_f32_16x16x32_bf16 v[4:7], v[132:135], v[48:51], v[4:7]
    v_mfma_f32_16x16x32_bf16 v[8:11], v[136:139], v[48:51], v[8:11]
    v_mfma_f32_16x16x32_bf16 v[12:15], v[140:143], v[48:51], v[12:15]
    ds_read_b64_tr_b16 v[128:129], v160 offset:9216
    ds_read_b64_tr_b16 v[130:131], v160 offset:10240
    ds_read_b64_tr_b16 v[132:133], v161 offset:9216
    ds_read_b64_tr_b16 v[134:135], v161 offset:10240
    ds_read_b64_tr_b16 v[136:137], v162 offset:9216
    ds_read_b64_tr_b16 v[138:139], v162 offset:10240
    ds_read_b64_tr_b16 v[140:141], v163 offset:9216
    ds_read_b64_tr_b16 v[142:143], v163 offset:10240
    s_waitcnt vmcnt(18) lgkmcnt(8)
    v_mfma_f32_16x16x32_bf16 v[0:3], v[144:147], v[52:55], v[0:3]
    v_mfma_f32_16x16x32_bf16 v[4:7], v[148:151], v[52:55], v[4:7]
    v_mfma_f32_16x16x32_bf16 v[8:11], v[152:155], v[52:55], v[8:11]
    v_mfma_f32_16x16x32_bf16 v[12:15], v[156:159], v[52:55], v[12:15]
    ds_read_b64_tr_b16 v[144:145], v164 offset:9216
    ds_read_b64_tr_b16 v[146:147], v164 offset:10240
    ds_read_b64_tr_b16 v[148:149], v165 offset:9216
    ds_read_b64_tr_b16 v[150:151], v165 offset:10240
    ds_read_b64_tr_b16 v[152:153], v166 offset:9216
    ds_read_b64_tr_b16 v[154:155], v166 offset:10240
    ds_read_b64_tr_b16 v[156:157], v167 offset:9216
    ds_read_b64_tr_b16 v[158:159], v167 offset:10240
    s_waitcnt vmcnt(17) lgkmcnt(8)
    v_mfma_f32_16x16x32_bf16 v[0:3], v[128:131], v[56:59], v[0:3]
    v_mfma_f32_16x16x32_bf16 v[4:7], v[132:135], v[56:59], v[4:7]
    v_mfma_f32_16x16x32_bf16 v[8:11], v[136:139], v[56:59], v[8:11]
    v_mfma_f32_16x16x32_bf16 v[12:15], v[140:143], v[56:59], v[12:15]
    ds_read_b64_tr_b16 v[128:129], v160 offset:18432
    ds_read_b64_tr_b16 v[130:131], v160 offset:19456
    ds_read_b64_tr_b16 v[132:133], v161 offset:18432
    ds_read_b64_tr_b16 v[134:135], v161 offset:19456
    ds_read_b64_tr_b16 v[136:137], v162 offset:18432
    ds_read_b64_tr_b16 v[138:139], v162 offset:19456
    ds_read_b64_tr_b16 v[140:141], v163 offset:18432
    ds_read_b64_tr_b16 v[142:143], v163 offset:19456
    s_waitcnt vmcnt(16) lgkmcnt(8)
    v_mfma_f32_16x16x32_bf16 v[0:3], v[144:147], v[60:63], v[0:3]
    v_mfma_f32_16x16x32_bf16 v[4:7], v[148:151], v[60:63], v[4:7]
    v_mfma_f32_16x16x32_bf16 v[8:11], v[152:155], v[60:63], v[8:11]
    v_mfma_f32_16x16x32_bf16 v[12:15], v[156:159], v[60:63], v[12:15]
    ds_read_b64_tr_b16 v[144:145], v164 offset:18432
    ds_read_b64_tr_b16 v[146:147], v164 offset:19456
    ds_read_b64_tr_b16 v[148:149], v165 offset:18432
    ds_read_b64_tr_b16 v[150:151], v165 offset:19456
    ds_read_b64_tr_b16 v[152:153], v166 offset:18432
    ds_read_b64_tr_b16 v[154:155], v166 offset:19456
    ds_read_b64_tr_b16 v[156:157], v167 offset:18432
    ds_read_b64_tr_b16 v[158:159], v167 offset:19456
    s_waitcnt vmcnt(15) lgkmcnt(8)
    v_mfma_f32_16x16x32_bf16 v[0:3], v[128:131], v[64:67], v[0:3]
    v_mfma_f32_16x16x32_bf16 v[4:7], v[132:135], v[64:67], v[4:7]
    v_mfma_f32_16x16x32_bf16 v[8:11], v[136:139], v[64:67], v[8:11]
    v_mfma_f32_16x16x32_bf16 v[12:15], v[140:143], v[64:67], v[12:15]
    ds_read_b64_tr_b16 v[128:129], v160 offset:27648
    ds_read_b64_tr_b16 v[130:131], v160 offset:28672
    ds_read_b64_tr_b16 v[132:133], v161 offset:27648
    ds_read_b64_tr_b16 v[134:135], v161 offset:28672
    ds_read_b64_tr_b16 v[136:137], v162 offset:27648
    ds_read_b64_tr_b16 v[138:139], v162 offset:28672
    ds_read_b64_tr_b16 v[140:141], v163 offset:27648
    ds_read_b64_tr_b16 v[142:143], v163 offset:28672
    s_waitcnt vmcnt(14) lgkmcnt(8)
    v_mfma_f32_16x16x32_bf16 v[0:3], v[144:147], v[68:71], v[0:3]
    v_mfma_f32_16x16x32_bf16 v[4:7], v[148:151], v[68:71], v[4:7]
    v_mfma_f32_16x16x32_bf16 v[8:11], v[152:155], v[68:71], v[8:11]
    v_mfma_f32_16x16x32_bf16 v[12:15], v[156:159], v[68:71], v[12:15]
    ds_read_b64_tr_b16 v[144:145], v164 offset:27648
    ds_read_b64_tr_b16 v[146:147], v164 offset:28672
    ds_read_b64_tr_b16 v[148:149], v165 offset:27648
    ds_read_b64_tr_b16 v[150:151], v165 offset:28672
    ds_read_b64_tr_b16 v[152:153], v166 offset:27648
    ds_read_b64_tr_b16 v[154:155], v166 offset:28672
    ds_read_b64_tr_b16 v[156:157], v167 offset:27648
    ds_read_b64_tr_b16 v[158:159], v167 offset:28672
    s_waitcnt vmcnt(13) lgkmcnt(8)
    v_mfma_f32_16x16x32_bf16 v[0:3], v[128:131], v[72:75], v[0:3]
    v_mfma_f32_16x16x32_bf16 v[4:7], v[132:135], v[72:75], v[4:7]
    v_mfma_f32_16x16x32_bf16 v[8:11], v[136:139], v[72:75], v[8:11]
    v_mfma_f32_16x16x32_bf16 v[12:15], v[140:143], v[72:75], v[12:15]
    ds_read_b64_tr_b16 v[128:129], v168 offset:0
    ds_read_b64_tr_b16 v[130:131], v172 offset:0
    ds_read_b64_tr_b16 v[132:133], v169 offset:0
    ds_read_b64_tr_b16 v[134:135], v173 offset:0
    ds_read_b64_tr_b16 v[136:137], v170 offset:0
    ds_read_b64_tr_b16 v[138:139], v174 offset:0
    ds_read_b64_tr_b16 v[140:141], v171 offset:0
    ds_read_b64_tr_b16 v[142:143], v175 offset:0
    s_waitcnt vmcnt(12) lgkmcnt(8)
    v_mfma_f32_16x16x32_bf16 v[0:3], v[144:147], v[76:79], v[0:3]
    v_mfma_f32_16x16x32_bf16 v[4:7], v[148:151], v[76:79], v[4:7]
    v_mfma_f32_16x16x32_bf16 v[8:11], v[152:155], v[76:79], v[8:11]
    v_mfma_f32_16x16x32_bf16 v[12:15], v[156:159], v[76:79], v[12:15]
    ds_read_b64_tr_b16 v[144:145], v168 offset:36864
    ds_read_b64_tr_b16 v[146:147], v172 offset:36864
    ds_read_b64_tr_b16 v[148:149], v169 offset:36864
    ds_read_b64_tr_b16 v[150:151], v173 offset:36864
    ds_read_b64_tr_b16 v[152:153], v170 offset:36864
    ds_read_b64_tr_b16 v[154:155], v174 offset:36864
    ds_read_b64_tr_b16 v[156:157], v171 offset:36864
    ds_read_b64_tr_b16 v[158:159], v175 offset:36864
    s_waitcnt vmcnt(11) lgkmcnt(8)
    v_mfma_f32_16x16x32_bf16 v[0:3], v[128:131], v[80:83], v[0:3]
    v_mfma_f32_16x16x32_bf16 v[4:7], v[132:135], v[80:83], v[4:7]
    v_mfma_f32_16x16x32_bf16 v[8:11], v[136:139], v[80:83], v[8:11]
    v_mfma_f32_16x16x32_bf16 v[12:15], v[140:143], v[80:83], v[12:15]
    s_waitcnt vmcnt(10) lgkmcnt(0)
    v_mfma_f32_16x16x32_bf16 v[0:3], v[144:147], v[84:87], v[0:3]
    v_mfma_f32_16x16x32_bf16 v[4:7], v[148:151], v[84:87], v[4:7]
    v_mfma_f32_16x16x32_bf16 v[8:11], v[152:155], v[84:87], v[8:11]
    v_mfma_f32_16x16x32_bf16 v[12:15], v[156:159], v[84:87], v[12:15]
    s_waitcnt vmcnt(8)
    v_lshlrev_b32 v176, 16, v88
    v_and_b32 v177, 0xffff0000, v88
    v_lshlrev_b32 v178, 16, v89
    v_and_b32 v179, 0xffff0000, v89
    v_lshlrev_b32 v180, 16, v90
    v_and_b32 v181, 0xffff0000, v90
    v_lshlrev_b32 v182, 16, v91
    v_and_b32 v183, 0xffff0000, v91
    v_lshlrev_b32 v184, 16, v92
    v_and_b32 v185, 0xffff0000, v92
    v_lshlrev_b32 v186, 16, v93
    v_and_b32 v187, 0xffff0000, v93
    v_lshlrev_b32 v188, 16, v94
    v_and_b32 v189, 0xffff0000, v94
    v_lshlrev_b32 v190, 16, v95
    v_and_b32 v191, 0xffff0000, v95
    s_waitcnt vmcnt(6)
    v_lshlrev_b32 v192, 16, v96
    v_and_b32 v193, 0xffff0000, v96
    v_lshlrev_b32 v194, 16, v97
    v_and_b32 v195, 0xffff0000, v97
    v_lshlrev_b32 v196, 16, v98
    v_and_b32 v197, 0xffff0000, v98
    v_lshlrev_b32 v198, 16, v99
    v_and_b32 v199, 0xffff0000, v99
    v_pk_add_f32 v[176:177], v[176:177], v[192:193]
    v_pk_add_f32 v[178:179], v[178:179], v[194:195]
    v_pk_add_f32 v[180:181], v[180:181], v[196:197]
    v_pk_add_f32 v[182:183], v[182:183], v[198:199]
    v_lshlrev_b32 v192, 16, v100
    v_and_b32 v193, 0xffff0000, v100
    v_lshlrev_b32 v194, 16, v101
    v_and_b32 v195, 0xffff0000, v101
    v_lshlrev_b32 v196, 16, v102
    v_and_b32 v197, 0xffff0000, v102
    v_lshlrev_b32 v198, 16, v103
    v_and_b32 v199, 0xffff0000, v103
    v_pk_add_f32 v[184:185], v[184:185], v[192:193]
    v_pk_add_f32 v[186:187], v[186:187], v[194:195]
    v_pk_add_f32 v[188:189], v[188:189], v[196:197]
    v_pk_add_f32 v[190:191], v[190:191], v[198:199]
    s_waitcnt vmcnt(4)
    v_lshlrev_b32 v192, 16, v104
    v_and_b32 v193, 0xffff0000, v104
    v_lshlrev_b32 v194, 16, v105
    v_and_b32 v195, 0xffff0000, v105
    v_lshlrev_b32 v196, 16, v106
    v_and_b32 v197, 0xffff0000, v106
    v_lshlrev_b32 v198, 16, v107
    v_and_b32 v199, 0xffff0000, v107
    v_pk_add_f32 v[176:177], v[176:177], v[192:193]
    v_pk_add_f32 v[178:179], v[178:179], v[194:195]
    v_pk_add_f32 v[180:181], v[180:181], v[196:197]
    v_pk_add_f32 v[182:183], v[182:183], v[198:199]
    v_lshlrev_b32 v192, 16, v108
    v_and_b32 v193, 0xffff0000, v108
    v_lshlrev_b32 v194, 16, v109
    v_and_b32 v195, 0xffff0000, v109
    v_lshlrev_b32 v196, 16, v110
    v_and_b32 v197, 0xffff0000, v110
    v_lshlrev_b32 v198, 16, v111
    v_and_b32 v199, 0xffff0000, v111
    v_pk_add_f32 v[184:185], v[184:185], v[192:193]
    v_pk_add_f32 v[186:187], v[186:187], v[194:195]
    v_pk_add_f32 v[188:189], v[188:189], v[196:197]
    v_pk_add_f32 v[190:191], v[190:191], v[198:199]
    s_waitcnt vmcnt(2)
    v_lshlrev_b32 v192, 16, v112
    v_and_b32 v193, 0xffff0000, v112
    v_lshlrev_b32 v194, 16, v113
    v_and_b32 v195, 0xffff0000, v113
    v_lshlrev_b32 v196, 16, v114
    v_and_b32 v197, 0xffff0000, v114
    v_lshlrev_b32 v198, 16, v115
    v_and_b32 v199, 0xffff0000, v115
    v_pk_add_f32 v[176:177], v[176:177], v[192:193]
    v_pk_add_f32 v[178:179], v[178:179], v[194:195]
    v_pk_add_f32 v[180:181], v[180:181], v[196:197]
    v_pk_add_f32 v[182:183], v[182:183], v[198:199]
    v_lshlrev_b32 v192, 16, v116
    v_and_b32 v193, 0xffff0000, v116
    v_lshlrev_b32 v194, 16, v117
    v_and_b32 v195, 0xffff0000, v117
    v_lshlrev_b32 v196, 16, v118
    v_and_b32 v197, 0xffff0000, v118
    v_lshlrev_b32 v198, 16, v119
    v_and_b32 v199, 0xffff0000, v119
    v_pk_add_f32 v[184:185], v[184:185], v[192:193]
    v_pk_add_f32 v[186:187], v[186:187], v[194:195]
    v_pk_add_f32 v[188:189], v[188:189], v[196:197]
    v_pk_add_f32 v[190:191], v[190:191], v[198:199]
    s_waitcnt vmcnt(0)
    v_lshlrev_b32 v192, 16, v120
    v_and_b32 v193, 0xffff0000, v120
    v_lshlrev_b32 v194, 16, v121
    v_and_b32 v195, 0xffff0000, v121
    v_lshlrev_b32 v196, 16, v122
    v_and_b32 v197, 0xffff0000, v122
    v_lshlrev_b32 v198, 16, v123
    v_and_b32 v199, 0xffff0000, v123
    v_pk_add_f32 v[176:177], v[176:177], v[192:193]
    v_pk_add_f32 v[178:179], v[178:179], v[194:195]
    v_pk_add_f32 v[180:181], v[180:181], v[196:197]
    v_pk_add_f32 v[182:183], v[182:183], v[198:199]
    v_lshlrev_b32 v192, 16, v124
    v_and_b32 v193, 0xffff0000, v124
    v_lshlrev_b32 v194, 16, v125
    v_and_b32 v195, 0xffff0000, v125
    v_lshlrev_b32 v196, 16, v126
    v_and_b32 v197, 0xffff0000, v126
    v_lshlrev_b32 v198, 16, v127
    v_and_b32 v199, 0xffff0000, v127
    v_pk_add_f32 v[184:185], v[184:185], v[192:193]
    v_pk_add_f32 v[186:187], v[186:187], v[194:195]
    v_pk_add_f32 v[188:189], v[188:189], v[196:197]
    v_pk_add_f32 v[190:191], v[190:191], v[198:199]
    v_permlane32_swap_b32 v0, v4
    v_permlane32_swap_b32 v1, v5
    v_permlane32_swap_b32 v2, v6
    v_permlane32_swap_b32 v3, v7
    v_permlane32_swap_b32 v8, v12
    v_permlane32_swap_b32 v9, v13
    v_permlane32_swap_b32 v10, v14
    v_permlane32_swap_b32 v11, v15
    s_nop 1
    v_pk_add_f32 v[176:177], v[176:177], v[0:1]
    v_pk_add_f32 v[178:179], v[178:179], v[2:3]
    v_pk_add_f32 v[180:181], v[180:181], v[4:5]
    v_pk_add_f32 v[182:183], v[182:183], v[6:7]
    v_pk_add_f32 v[184:185], v[184:185], v[8:9]
    v_pk_add_f32 v[186:187], v[186:187], v[10:11]
    v_pk_add_f32 v[188:189], v[188:189], v[12:13]
    v_pk_add_f32 v[190:191], v[190:191], v[14:15]
    v_cvt_pk_bf16_f32 v192, v176, v177
    v_cvt_pk_bf16_f32 v193, v178, v179
    v_cvt_pk_bf16_f32 v194, v180, v181
    v_cvt_pk_bf16_f32 v195, v182, v183
    v_cvt_pk_bf16_f32 v196, v184, v185
    v_cvt_pk_bf16_f32 v197, v186, v187
    v_cvt_pk_bf16_f32 v198, v188, v189
    v_cvt_pk_bf16_f32 v199, v190, v191
    s_nop 1
    v_permlane16_swap_b32 v192, v194
    v_permlane16_swap_b32 v193, v195
    v_permlane16_swap_b32 v196, v198
    v_permlane16_swap_b32 v197, v199
    s_nop 1
    buffer_store_dwordx4 v[192:195], v203, s[32:35], s54 offen offset:0
    buffer_store_dwordx4 v[196:199], v203, s[32:35], s54 offen offset:64
K3_EXIT:
    s_endpgm
.section .rodata,"a"
.p2align 6
.amdhsa_kernel k1_kernel
  .amdhsa_next_free_vgpr 256
  .amdhsa_next_free_sgpr 102
  .amdhsa_accum_offset 256
  .amdhsa_group_segment_fixed_size 0
  .amdhsa_kernarg_size 96
  .amdhsa_user_sgpr_count 2
  .amdhsa_user_sgpr_kernarg_segment_ptr 1
  .amdhsa_system_sgpr_workgroup_id_x 1
.end_amdhsa_kernel
.p2align 6
.amdhsa_kernel k2_kernel
  .amdhsa_next_free_vgpr 256
  .amdhsa_next_free_sgpr 102
  .amdhsa_accum_offset 256
  .amdhsa_group_segment_fixed_size 0
  .amdhsa_kernarg_size 96
  .amdhsa_user_sgpr_count 2
  .amdhsa_user_sgpr_kernarg_segment_ptr 1
  .amdhsa_system_sgpr_workgroup_id_x 1
.end_amdhsa_kernel
.p2align 6
.amdhsa_kernel k3_kernel
  .amdhsa_next_free_vgpr 216
  .amdhsa_next_free_sgpr 102
  .amdhsa_accum_offset 216
  .amdhsa_group_segment_fixed_size 0
  .amdhsa_kernarg_size 96
  .amdhsa_user_sgpr_count 2
  .amdhsa_user_sgpr_kernarg_segment_ptr 1
  .amdhsa_system_sgpr_workgroup_id_x 1
.end_amdhsa_kernel
```
